```python
import torch

def _softmax(x, axis=-1):
    return torch.softmax(x, dim=axis)
def _gelu(x):
    return torch.nn.functional.gelu(x, approximate="tanh")
def _silu(x):
    return torch.nn.functional.silu(x)
def _sigmoid(x):
    return torch.sigmoid(x)
def _layernorm(x, axis=-1, eps=1e-5):
    m = x.mean(dim=axis, keepdim=True)
    v = x.var(dim=axis, keepdim=True, unbiased=False)
    return (x - m) / torch.sqrt(v + eps)
def _scatter_add(tgt, idx, src, axis=0):
    return tgt.clone().index_add_(axis, idx, src)
def _segment_sum(src, seg, n):
    out = torch.zeros((n,) + src.shape[1:], dtype=src.dtype)
    return out.index_add_(0, seg, src)
def _pad(x, pw):
    flat = tuple(v for pair in reversed(pw) for v in pair)
    return torch.nn.functional.pad(x, flat)

kernel_name = 'sequential_preLN__sliding_block__glu_gated_bilinear__prompt'

def setup_inputs():

    _w = (lambda a: (lambda t: t.to(torch.bfloat16) if t.is_floating_point() else t)(torch.as_tensor(a)))
    def _A_setup():
        B, S, D = 1, 2048, 640
        return {
            "x": _w((lambda *s: torch.randn(*s, dtype=torch.bfloat16) * 0.05)(B, S, D)),
            "wqkv": _w((lambda *s: torch.randn(*s, dtype=torch.bfloat16) * 0.05)(D, 3 * D)),
            "wo": _w((lambda *s: torch.randn(*s, dtype=torch.bfloat16) * 0.05)(D, D)),
        }
    _A_in = _A_setup()

    def _B_setup():
        B, S, D, F = 1, 2048, 640, 1728
        return {
            "x": _w((lambda *s: torch.randn(*s, dtype=torch.bfloat16) * 0.05)(B, S, D)),
            "w_gate": _w((lambda *s: torch.randn(*s, dtype=torch.bfloat16) * 0.8)(D, F) * (D ** -0.5)),
            "w_up": _w((lambda *s: torch.randn(*s, dtype=torch.bfloat16) * 0.8)(D, F) * (D ** -0.5)),
            "w_down": _w((lambda *s: torch.randn(*s, dtype=torch.bfloat16) * 0.8)(F, D) * (F ** -0.5)),
        }
    _B_in = _B_setup()

    return {
        "A_x": _A_in["x"],
        "A_wqkv": _A_in["wqkv"],
        "A_wo": _A_in["wo"],
        "B_x": _B_in["x"],
        "B_w_gate": _B_in["w_gate"],
        "B_w_up": _B_in["w_up"],
        "B_w_down": _B_in["w_down"],
    }

def reference(A_x, A_wqkv, A_wo, B_x, B_w_gate, B_w_up, B_w_down):
    def _A_ref(x, wqkv, wo):
        B, S, D = x.shape
        H = 32; Dh = D // H; W = 256
        qkv = (lambda x, *d: x.permute(*d))((x @ wqkv).reshape(B, S, 3, H, Dh), 2, 0, 3, 1, 4)
        q, k, v = qkv[0], qkv[1], qkv[2]
        scores = torch.einsum("bhqd,bhkd->bhqk", q, k) * (Dh ** -0.5)
        idx = torch.arange(S)
        mask = (idx[:, None] - idx[None, :] >= 0) & (idx[:, None] - idx[None, :] < W)
        scores = torch.where(mask[None, None], scores, -1e9)
        p = _softmax(scores, axis=-1)
        o = torch.einsum("bhqk,bhkd->bhqd", p, v)
        return (lambda x, *d: x.permute(*d))(o, 0, 2, 1, 3).reshape(B, S, D) @ wo

    def _B_ref(x, w_gate, w_up, w_down):
        g = torch.einsum("bsd,df->bsf", x, w_gate)
        u = torch.einsum("bsd,df->bsf", x, w_up)
        h = g * u
        return torch.einsum("bsf,fd->bsd", h, w_down)

    x = A_x
    h = x + _A_ref(_layernorm(x, axis=-1), A_wqkv, A_wo)
    h2 = h + _B_ref(_layernorm(h, axis=-1), B_w_gate, B_w_up, B_w_down)
    return h2
```

```asm
; @launch grid=(256,1,1) block=(512,1,1) lds=163840
.amdgcn_target "amdgcn-amd-amdhsa--gfx950"
.text
.globl sequential_preLN__sliding_block__glu_gated_bilinear__prompt_kernel
.p2align 8
.type sequential_preLN__sliding_block__glu_gated_bilinear__prompt_kernel,@function
sequential_preLN__sliding_block__glu_gated_bilinear__prompt_kernel:
    s_cmp_ge_u32 s2, 256
    s_cbranch_scc1 Lend
    s_load_dwordx16 s[32:47], s[0:1], 0
    s_load_dwordx4 s[48:51], s[0:1], 64
    v_lshrrev_b32 v1, 6, v0
    v_and_b32 v0, 63, v0
    v_readfirstlane_b32 s30, v1
    s_cmp_lg_u32 s30, 7
    s_cbranch_scc1 Lnocpf_1
    s_getpc_b64 s[52:53]
Lpcbase:
    s_lshr_b32 s54, s2, 3
    s_mul_i32 s54, s54, 10
    v_min_u32 v2, 9, v0
    v_add_u32 v2, s54, v2
    v_lshlrev_b32 v2, 7, v2
    v_min_u32 v2, Lcodeend-Lpcbase-4, v2
    global_load_dword v252, v2, s[52:53]
Lnocpf_1:
    s_and_b32 s3, s2, 7
    s_lshr_b32 s31, s2, 3
    s_lshr_b32 s52, s3, 1
    s_lshl_b32 s52, s52, 2
    s_lshr_b32 s53, s31, 3
    s_add_u32 s28, s52, s53
    s_and_b32 s52, s31, 7
    s_lshl_b32 s52, s52, 1
    s_and_b32 s53, s3, 1
    s_add_u32 s29, s52, s53
    s_cmp_eq_u32 s29, 15
    s_cbranch_scc1 Lp1aux_2
    s_cmp_lt_u32 s30, 4
    s_cbranch_scc1 Lp1ld_3
    s_sub_u32 s31, s30, 4
    v_lshrrev_b32 v1, 3, v0
    v_lshrrev_b32 v2, 4, v0
    v_and_b32 v3, 7, v0
    s_lshl_b32 s52, s31, 5
    v_add_u32 v4, s52, v1
    s_movk_i32 s53, 1280
    v_mul_lo_u32 v4, v4, s53
    v_add_u32 v5, 0, v2
    v_and_b32 v5, 7, v5
    v_xor_b32 v5, v5, v3
    v_lshl_add_u32 v10, v5, 4, v4
    v_add_u32 v5, 4, v2
    v_and_b32 v5, 7, v5
    v_xor_b32 v5, v5, v3
    v_lshl_add_u32 v11, v5, 4, v4
    v_add_u32 v11, 9216, v11
    v_add_u32 v5, 8, v2
    v_and_b32 v5, 7, v5
    v_xor_b32 v5, v5, v3
    v_lshl_add_u32 v12, v5, 4, v4
    v_add_u32 v12, 18432, v12
    v_add_u32 v5, 12, v2
    v_and_b32 v5, 7, v5
    v_xor_b32 v5, v5, v3
    v_lshl_add_u32 v13, v5, 4, v4
    v_add_u32 v13, 27648, v13
    s_lshl_b32 s52, s31, 4
    v_add_u32 v4, s52, v2
    s_movk_i32 s53, 3840
    v_mul_lo_u32 v4, v4, s53
    v_and_b32 v5, 15, v0
    v_lshlrev_b32 v6, 2, v2
    v_xor_b32 v5, v5, v6
    v_lshl_add_u32 v14, v5, 4, v4
    v_add_u32 v15, 14336, v14
    v_add_u32 v16, 28672, v14
    v_add_u32 v17, 43008, v14
    s_mul_i32 s54, s28, 163840
    s_lshl_b32 s55, s29, 8
    s_lshl_b32 s56, s31, 12
    s_waitcnt lgkmcnt(0)
    s_mov_b32 s4, s32
    s_and_b32 s5, s33, 0xffff
    s_mov_b32 s6, 2621440
    s_mov_b32 s7, 0x20000
    s_mov_b32 s8, s34
    s_and_b32 s9, s35, 0xffff
    s_mov_b32 s10, 2457600
    s_mov_b32 s11, 0x20000
    s_mov_b32 s57, 0
Lp1i_5:
    s_mov_b32 m0, s56
    s_nop 0
    buffer_load_dwordx4 v10, s[4:7], s54 offen offset:0 lds
    buffer_load_dwordx4 v11, s[4:7], s54 offen offset:1024 lds
    buffer_load_dwordx4 v12, s[4:7], s54 offen offset:2048 lds
    buffer_load_dwordx4 v13, s[4:7], s54 offen offset:3072 lds
    s_add_u32 m0, s56, 16384
    s_nop 0
    buffer_load_dwordx4 v14, s[8:11], s55 offen offset:0 lds
    buffer_load_dwordx4 v15, s[8:11], s55 offen offset:1024 lds
    buffer_load_dwordx4 v16, s[8:11], s55 offen offset:2048 lds
    buffer_load_dwordx4 v17, s[8:11], s55 offen offset:3072 lds
    s_add_u32 s54, s54, 128
    s_add_u32 s55, s55, 245760
    s_add_u32 s56, s56, 32768
    s_and_b32 s56, s56, 0x1ffff
    s_add_u32 s57, s57, 1
    s_cmp_lt_u32 s57, 3
    s_cbranch_scc1 Lp1i_5
    s_mov_b32 s16, s50
    s_and_b32 s17, s51, 0xffff
    s_mov_b32 s18, 34603008
    s_mov_b32 s19, 0x20000
    s_mov_b32 s24, s48
    s_and_b32 s25, s49, 0xffff
    s_mov_b32 s26, 256
    s_mov_b32 s27, 0x20000
    s_mov_b32 s20, s46
    s_and_b32 s21, s47, 0xffff
    s_mov_b32 s22, 2621440
    s_mov_b32 s23, 0x20000
    s_mov_b32 s57, 0
Lp1l_6:
    s_cmp_lt_u32 s57, 8
    s_cbranch_scc0 Lw8_7
    s_waitcnt vmcnt(16)
    s_branch Lwd_9
Lw8_7:
    s_cmp_eq_u32 s57, 8
    s_cbranch_scc0 Lw0_8
    s_waitcnt vmcnt(8)
    s_branch Lwd_9
Lw0_8:
    s_waitcnt vmcnt(0)
Lwd_9:
    s_barrier
    s_cmp_lt_u32 s57, 7
    s_cbranch_scc0 Lnoiss_10
    s_mov_b32 m0, s56
    s_nop 0
    buffer_load_dwordx4 v10, s[4:7], s54 offen offset:0 lds
    buffer_load_dwordx4 v11, s[4:7], s54 offen offset:1024 lds
    buffer_load_dwordx4 v12, s[4:7], s54 offen offset:2048 lds
    buffer_load_dwordx4 v13, s[4:7], s54 offen offset:3072 lds
    s_add_u32 m0, s56, 16384
    s_nop 0
    buffer_load_dwordx4 v14, s[8:11], s55 offen offset:0 lds
    buffer_load_dwordx4 v15, s[8:11], s55 offen offset:1024 lds
    buffer_load_dwordx4 v16, s[8:11], s55 offen offset:2048 lds
    buffer_load_dwordx4 v17, s[8:11], s55 offen offset:3072 lds
    s_add_u32 s54, s54, 128
    s_add_u32 s55, s55, 245760
    s_add_u32 s56, s56, 32768
    s_and_b32 s56, s56, 0x1ffff
Lnoiss_10:
    s_add_u32 s57, s57, 1
    s_cmp_lt_u32 s57, 10
    s_cbranch_scc1 Lp1l_6
    s_barrier
    s_cmp_lg_u32 s30, 4
    s_cbranch_scc1 Lnoini_11
    v_and_b32 v2, 15, v0
    v_lshlrev_b32 v2, 2, v2
    v_mov_b32 v3, 1
    s_mov_b32 s52, 40000
Lpoll_12:
    buffer_load_dword v1, v2, s[24:27], 0 offen sc1
    s_waitcnt vmcnt(0)
    v_cmp_le_u32 vcc, v3, v1
    s_cmp_eq_u64 vcc, -1
    s_cbranch_scc1 Lpolld_13
    s_sleep 1
    s_sub_u32 s52, s52, 1
    s_cmp_lg_u32 s52, 0
    s_cbranch_scc1 Lpoll_12
Lpolld_13:
Lnoini_11:
    s_barrier
    s_cmp_lg_u32 s30, 4
    s_cbranch_scc1 Lnosig_14
    s_lshl_b32 s52, s28, 6
    s_add_u32 s52, s52, s29
    s_add_u32 s52, s52, 0
    s_mul_i32 s52, s52, 128
    s_add_u32 s52, s52, 131072
    v_mov_b32 v1, 1
    s_mov_b64 exec, 1
    buffer_store_dword v1, off, s[16:19], s52 sc1
    s_mov_b64 exec, -1
Lnosig_14:
    s_branch Lp2_4
Lp1ld_3:
    s_and_b32 s54, s30, 1
    s_lshr_b32 s55, s30, 1
    v_and_b32 v1, 31, v0
    s_lshl_b32 s52, s54, 6
    v_add_u32 v2, s52, v1
    v_lshlrev_b32 v2, 7, v2
    v_bfe_u32 v3, v0, 1, 3
    v_lshrrev_b32 v4, 5, v0
    v_add_u32 v5, 0, v4
    v_xor_b32 v5, v5, v3
    v_lshl_add_u32 v40, v5, 4, v2
    v_add_u32 v5, 2, v4
    v_xor_b32 v5, v5, v3
    v_lshl_add_u32 v41, v5, 4, v2
    v_add_u32 v5, 4, v4
    v_xor_b32 v5, v5, v3
    v_lshl_add_u32 v42, v5, 4, v2
    v_add_u32 v5, 6, v4
    v_xor_b32 v5, v5, v3
    v_lshl_add_u32 v43, v5, 4, v2
    v_lshrrev_b32 v1, 4, v0
    v_bfe_u32 v2, v0, 2, 2
    v_and_b32 v3, 3, v0
    v_lshrrev_b32 v4, 1, v1
    v_lshl_add_u32 v4, v4, 3, v2
    v_lshlrev_b32 v4, 8, v4
    v_add_u32 v4, 16384, v4
    v_and_b32 v5, 1, v3
    v_lshl_add_u32 v4, v5, 3, v4
    v_and_b32 v5, 1, v1
    v_lshlrev_b32 v5, 1, v5
    v_lshrrev_b32 v6, 1, v3
    v_add_u32 v5, v5, v6
    s_lshl_b32 s52, s55, 3
    s_lshl_b32 s53, s54, 2
    s_add_u32 s52, s52, s53
    v_add_u32 v5, s52, v5
    v_lshlrev_b32 v6, 2, v2
    v_xor_b32 v5, v5, v6
    v_lshl_add_u32 v44, v5, 4, v4
    v_xor_b32 v45, 64, v44
    v_and_b32 v5, 15, v0
    v_and_b32 v6, 1, v1
    v_cmp_eq_u32 vcc, v5, v6
    v_mov_b32 v7, 0x3f803f80
    s_nop 0
    v_cndmask_b32 v56, 0, v7, vcc
    v_mov_b32 v57, v56
    v_mov_b32 v58, v56
    v_mov_b32 v59, v56
    v_mov_b32 v64, 0
    v_mov_b32 v65, 0
    v_mov_b32 v66, 0
    v_mov_b32 v67, 0
    v_mov_b32 v68, 0
    v_mov_b32 v69, 0
    v_mov_b32 v70, 0
    v_mov_b32 v71, 0
    v_mov_b32 v72, 0
    v_mov_b32 v73, 0
    v_mov_b32 v74, 0
    v_mov_b32 v75, 0
    v_mov_b32 v76, 0
    v_mov_b32 v77, 0
    v_mov_b32 v78, 0
    v_mov_b32 v79, 0
    v_mov_b32 v80, 0
    v_mov_b32 v81, 0
    v_mov_b32 v82, 0
    v_mov_b32 v83, 0
    v_mov_b32 v84, 0
    v_mov_b32 v85, 0
    v_mov_b32 v86, 0
    v_mov_b32 v87, 0
    v_mov_b32 v88, 0
    v_mov_b32 v89, 0
    v_mov_b32 v90, 0
    v_mov_b32 v91, 0
    v_mov_b32 v92, 0
    v_mov_b32 v93, 0
    v_mov_b32 v94, 0
    v_mov_b32 v95, 0
    v_mov_b32 v96, 0
    v_mov_b32 v97, 0
    v_mov_b32 v98, 0
    v_mov_b32 v99, 0
    v_mov_b32 v100, 0
    v_mov_b32 v101, 0
    v_mov_b32 v102, 0
    v_mov_b32 v103, 0
    v_mov_b32 v104, 0
    v_mov_b32 v105, 0
    v_mov_b32 v106, 0
    v_mov_b32 v107, 0
    v_mov_b32 v108, 0
    v_mov_b32 v109, 0
    v_mov_b32 v110, 0
    v_mov_b32 v111, 0
    v_mov_b32 v112, 0
    v_mov_b32 v113, 0
    v_mov_b32 v114, 0
    v_mov_b32 v115, 0
    v_mov_b32 v116, 0
    v_mov_b32 v117, 0
    v_mov_b32 v118, 0
    v_mov_b32 v119, 0
    v_mov_b32 v120, 0
    v_mov_b32 v121, 0
    v_mov_b32 v122, 0
    v_mov_b32 v123, 0
    v_mov_b32 v124, 0
    v_mov_b32 v125, 0
    v_mov_b32 v126, 0
    v_mov_b32 v127, 0
    v_mov_b32 v60, 0
    v_mov_b32 v61, 0
    v_mov_b32 v62, 0
    v_mov_b32 v63, 0
    s_mov_b32 s56, 0
    v_and_b32 v1, 31, v0
    v_lshlrev_b32 v197, 3, v1
    s_lshl_b32 s61, s28, 7
    s_lshl_b32 s62, s54, 6
    s_add_u32 s61, s61, s62
    s_lshl_b32 s61, s61, 3
    s_add_u32 s61, s61, 393216
    s_lshl_b32 s63, s28, 2
    s_add_u32 s63, s63, 64
    s_mov_b32 s60, 0
    s_waitcnt lgkmcnt(0)
    s_mov_b32 s4, s32
    s_and_b32 s5, s33, 0xffff
    s_mov_b32 s6, 2621440
    s_mov_b32 s7, 0x20000
    s_mov_b32 s8, s34
    s_and_b32 s9, s35, 0xffff
    s_mov_b32 s10, 2457600
    s_mov_b32 s11, 0x20000
    s_mov_b32 s16, s50
    s_and_b32 s17, s51, 0xffff
    s_mov_b32 s18, 34603008
    s_mov_b32 s19, 0x20000
    s_mov_b32 s24, s48
    s_and_b32 s25, s49, 0xffff
    s_mov_b32 s26, 256
    s_mov_b32 s27, 0x20000
    s_mov_b32 s20, s46
    s_and_b32 s21, s47, 0xffff
    s_mov_b32 s22, 2621440
    s_mov_b32 s23, 0x20000
    s_cmp_lg_u32 s29, 0
    s_cbranch_scc1 Lnoinit_15
    s_cmp_lg_u32 s30, 0
    s_cbranch_scc1 Lnoinit_15
    v_lshlrev_b32 v1, 12, v0
    s_lshl_b32 s52, s28, 8
    v_add_u32 v1, s52, v1
    v_mov_b32 v2, 0
    s_mov_b64 exec, 0xf
    buffer_store_dword v2, v1, s[16:19], 0 offen sc1
    s_mov_b64 exec, -1
    v_mul_u32_u24 v1, 128, v0
    s_mul_i32 s52, s28, 8192
    s_add_u32 s52, s52, 131072
    buffer_store_dword v2, v1, s[16:19], s52 offen sc1
    s_cmp_lg_u32 s28, 0
    s_cbranch_scc1 Lnoaux_16
    s_mov_b64 exec, 7
    v_lshlrev_b32 v1, 8, v0
    v_add_u32 v1, 16384, v1
    buffer_store_dword v2, v1, s[16:19], 0 offen sc1
Lnoaux_16:
    s_waitcnt vmcnt(0)
    s_mov_b64 exec, 1
    s_lshl_b32 s52, s28, 2
    v_mov_b32 v2, 1
    buffer_store_dword v2, off, s[24:27], s52 sc1
    s_mov_b64 exec, -1
Lnoinit_15:
    s_cmp_lg_u32 s30, 1
    s_cbranch_scc1 Lpf1c_17
    s_mul_i32 s52, s2, 10240
    v_lshlrev_b32 v1, 7, v0
    buffer_load_dword v250, v1, s[4:7], s52 offen
    v_add_u32 v1, 64, v0
    v_min_u32 v1, 79, v1
    v_lshlrev_b32 v1, 7, v1
    buffer_load_dword v250, v1, s[4:7], s52 offen
    s_mul_i32 s52, s2, 9600
    v_lshlrev_b32 v1, 7, v0
    buffer_load_dword v251, v1, s[8:11], s52 offen
    v_add_u32 v1, 64, v0
    v_min_u32 v1, 74, v1
    v_lshlrev_b32 v1, 7, v1
    buffer_load_dword v251, v1, s[8:11], s52 offen
Lpf1c_17:
    v_and_b32 v1, 15, v0
    v_lshrrev_b32 v2, 4, v0
    v_lshlrev_b32 v2, 4, v2
    v_lshl_add_u32 v2, v1, 6, v2
    s_lshl_b32 s52, s55, 1
    s_add_u32 s52, s52, s54
    s_lshl_b32 s52, s52, 7
    s_add_u32 s52, s52, 132096
    v_add_u32 v46, s52, v2
    v_cmp_gt_u32 s[76:77], 2, v1
    v_lshrrev_b32 v1, 5, v0
    v_lshlrev_b32 v2, 4, v1
    v_add_u32 v47, s52, v2
    v_xor_b32 v48, 128, v47
    v_and_b32 v5, 31, v0
    v_lshlrev_b32 v7, 15, v1
    v_lshl_add_u32 v49, v5, 4, v7
    s_mov_b32 s64, 0x3ea52b87
    s_cmp_lt_u32 s29, 5
    s_cselect_b32 s64, s64, 1.0
    s_lshl_b32 s53, s29, 4
    s_lshl_b32 s57, s55, 3
    s_add_u32 s53, s53, s57
    s_lshl_b32 s57, s54, 2
    s_add_u32 s65, s53, s57
    s_xor_b32 s57, s57, 4
    s_add_u32 s66, s53, s57
    s_lshl_b32 s65, s65, 15
    s_lshl_b32 s66, s66, 15
    s_lshl_b32 s53, s28, 7
    s_lshl_b32 s57, s54, 6
    s_add_u32 s53, s53, s57
    s_lshl_b32 s53, s53, 4
    s_add_u32 s53, s53, 5242880
    s_add_u32 s65, s65, s53
    s_add_u32 s66, s66, s53
    s_barrier
    ds_read_b64_tr_b16 v[136:137], v44 offset:0
    ds_read_b64_tr_b16 v[138:139], v44 offset:1024
    ds_read_b64_tr_b16 v[140:141], v45 offset:0
    ds_read_b64_tr_b16 v[142:143], v45 offset:1024
    ds_read_b128 v[128:131], v40 offset:0
    ds_read_b128 v[132:135], v40 offset:4096
    ds_read_b64_tr_b16 v[152:153], v44 offset:4096
    ds_read_b64_tr_b16 v[154:155], v44 offset:5120
    ds_read_b64_tr_b16 v[156:157], v45 offset:4096
    ds_read_b64_tr_b16 v[158:159], v45 offset:5120
    ds_read_b128 v[144:147], v41 offset:0
    ds_read_b128 v[148:151], v41 offset:4096
Lp1c_18:
    s_waitcnt lgkmcnt(6)
    v_mfma_f32_32x32x16_bf16 v[64:79], v[136:139], v[128:131], v[64:79]
    ds_read_b64_tr_b16 v[168:169], v44 offset:8192
    ds_read_b64_tr_b16 v[170:171], v44 offset:9216
    ds_read_b64_tr_b16 v[172:173], v45 offset:8192
    v_mfma_f32_32x32x16_bf16 v[80:95], v[136:139], v[132:135], v[80:95]
    ds_read_b64_tr_b16 v[174:175], v45 offset:9216
    ds_read_b128 v[160:163], v42 offset:0
    ds_read_b128 v[164:167], v42 offset:4096
    v_mfma_f32_32x32x16_bf16 v[96:111], v[140:143], v[128:131], v[96:111]
    v_mfma_f32_32x32x16_bf16 v[112:127], v[140:143], v[132:135], v[112:127]
    v_mfma_f32_16x16x32_bf16 v[60:63], v[136:139], v[56:59], v[60:63]
    s_waitcnt lgkmcnt(6)
    v_mfma_f32_32x32x16_bf16 v[64:79], v[152:155], v[144:147], v[64:79]
    ds_read_b64_tr_b16 v[184:185], v44 offset:12288
    ds_read_b64_tr_b16 v[186:187], v44 offset:13312
    ds_read_b64_tr_b16 v[188:189], v45 offset:12288
    v_mfma_f32_32x32x16_bf16 v[80:95], v[152:155], v[148:151], v[80:95]
    ds_read_b64_tr_b16 v[190:191], v45 offset:13312
    ds_read_b128 v[176:179], v43 offset:0
    ds_read_b128 v[180:183], v43 offset:4096
    v_mfma_f32_32x32x16_bf16 v[96:111], v[156:159], v[144:147], v[96:111]
    v_mfma_f32_32x32x16_bf16 v[112:127], v[156:159], v[148:151], v[112:127]
    v_mfma_f32_16x16x32_bf16 v[60:63], v[152:155], v[56:59], v[60:63]
    s_waitcnt lgkmcnt(0)
    s_barrier
    v_mfma_f32_32x32x16_bf16 v[64:79], v[168:171], v[160:163], v[64:79]
    ds_read_b64_tr_b16 v[136:137], v44 offset:32768
    ds_read_b64_tr_b16 v[138:139], v44 offset:33792
    ds_read_b64_tr_b16 v[140:141], v45 offset:32768
    v_mfma_f32_32x32x16_bf16 v[80:95], v[168:171], v[164:167], v[80:95]
    ds_read_b64_tr_b16 v[142:143], v45 offset:33792
    ds_read_b128 v[128:131], v40 offset:32768
    ds_read_b128 v[132:135], v40 offset:36864
    v_mfma_f32_32x32x16_bf16 v[96:111], v[172:175], v[160:163], v[96:111]
    v_mfma_f32_32x32x16_bf16 v[112:127], v[172:175], v[164:167], v[112:127]
    v_mfma_f32_16x16x32_bf16 v[60:63], v[168:171], v[56:59], v[60:63]
    v_mfma_f32_32x32x16_bf16 v[64:79], v[184:187], v[176:179], v[64:79]
    ds_read_b64_tr_b16 v[152:153], v44 offset:36864
    ds_read_b64_tr_b16 v[154:155], v44 offset:37888
    ds_read_b64_tr_b16 v[156:157], v45 offset:36864
    v_mfma_f32_32x32x16_bf16 v[80:95], v[184:187], v[180:183], v[80:95]
    ds_read_b64_tr_b16 v[158:159], v45 offset:37888
    ds_read_b128 v[144:147], v41 offset:32768
    ds_read_b128 v[148:151], v41 offset:36864
    v_mfma_f32_32x32x16_bf16 v[96:111], v[188:191], v[176:179], v[96:111]
    v_mfma_f32_32x32x16_bf16 v[112:127], v[188:191], v[180:183], v[112:127]
    v_mfma_f32_16x16x32_bf16 v[60:63], v[184:187], v[56:59], v[60:63]
    s_cmp_lt_u32 s56, 2
    s_cbranch_scc1 Lsfo_19
    s_branch Lsfx_21
Lsfo_19:
    s_waitcnt lgkmcnt(6)
    v_mfma_f32_32x32x16_bf16 v[64:79], v[136:139], v[128:131], v[64:79]
    ds_read_b64_tr_b16 v[168:169], v44 offset:40960
    ds_read_b64_tr_b16 v[170:171], v44 offset:41984
    ds_read_b64_tr_b16 v[172:173], v45 offset:40960
    v_mfma_f32_32x32x16_bf16 v[80:95], v[136:139], v[132:135], v[80:95]
    ds_read_b64_tr_b16 v[174:175], v45 offset:41984
    ds_read_b128 v[160:163], v42 offset:32768
    ds_read_b128 v[164:167], v42 offset:36864
    v_mfma_f32_32x32x16_bf16 v[96:111], v[140:143], v[128:131], v[96:111]
    v_mfma_f32_32x32x16_bf16 v[112:127], v[140:143], v[132:135], v[112:127]
    v_mfma_f32_16x16x32_bf16 v[60:63], v[136:139], v[56:59], v[60:63]
    s_waitcnt lgkmcnt(6)
    v_mfma_f32_32x32x16_bf16 v[64:79], v[152:155], v[144:147], v[64:79]
    ds_read_b64_tr_b16 v[184:185], v44 offset:45056
    ds_read_b64_tr_b16 v[186:187], v44 offset:46080
    ds_read_b64_tr_b16 v[188:189], v45 offset:45056
    v_mfma_f32_32x32x16_bf16 v[80:95], v[152:155], v[148:151], v[80:95]
    ds_read_b64_tr_b16 v[190:191], v45 offset:46080
    ds_read_b128 v[176:179], v43 offset:32768
    ds_read_b128 v[180:183], v43 offset:36864
    v_mfma_f32_32x32x16_bf16 v[96:111], v[156:159], v[144:147], v[96:111]
    v_mfma_f32_32x32x16_bf16 v[112:127], v[156:159], v[148:151], v[112:127]
    v_mfma_f32_16x16x32_bf16 v[60:63], v[152:155], v[56:59], v[60:63]
    s_waitcnt lgkmcnt(0)
    v_xor_b32 v40, 0x10000, v40
    v_xor_b32 v41, 0x10000, v41
    v_xor_b32 v42, 0x10000, v42
    v_xor_b32 v43, 0x10000, v43
    v_xor_b32 v44, 0x10000, v44
    v_xor_b32 v45, 0x10000, v45
    s_cmp_eq_u32 s56, 4
    s_cbranch_scc1 Lnb_22
    s_barrier
Lnb_22:
    v_mfma_f32_32x32x16_bf16 v[64:79], v[168:171], v[160:163], v[64:79]
    ds_read_b64_tr_b16 v[136:137], v44 offset:0
    ds_read_b64_tr_b16 v[138:139], v44 offset:1024
    ds_read_b64_tr_b16 v[140:141], v45 offset:0
    v_mfma_f32_32x32x16_bf16 v[80:95], v[168:171], v[164:167], v[80:95]
    ds_read_b64_tr_b16 v[142:143], v45 offset:1024
    ds_read_b128 v[128:131], v40 offset:0
    ds_read_b128 v[132:135], v40 offset:4096
    v_mfma_f32_32x32x16_bf16 v[96:111], v[172:175], v[160:163], v[96:111]
    v_mfma_f32_32x32x16_bf16 v[112:127], v[172:175], v[164:167], v[112:127]
    v_mfma_f32_16x16x32_bf16 v[60:63], v[168:171], v[56:59], v[60:63]
    v_mfma_f32_32x32x16_bf16 v[64:79], v[184:187], v[176:179], v[64:79]
    ds_read_b64_tr_b16 v[152:153], v44 offset:4096
    ds_read_b64_tr_b16 v[154:155], v44 offset:5120
    ds_read_b64_tr_b16 v[156:157], v45 offset:4096
    v_mfma_f32_16x16x32_bf16 v[60:63], v[184:187], v[56:59], v[60:63]
    v_mfma_f32_32x32x16_bf16 v[80:95], v[184:187], v[180:183], v[80:95]
    ds_read_b64_tr_b16 v[158:159], v45 offset:5120
    ds_read_b128 v[144:147], v41 offset:0
    ds_read_b128 v[148:151], v41 offset:4096
    v_mfma_f32_32x32x16_bf16 v[96:111], v[188:191], v[176:179], v[96:111]
    v_mfma_f32_32x32x16_bf16 v[112:127], v[188:191], v[180:183], v[112:127]
    s_add_u32 s56, s56, 1
    s_cmp_lt_u32 s56, 5
    s_cbranch_scc1 Lp1c_18
    s_mov_b64 exec, s[76:77]
    ds_write_b128 v46, v[60:63]
    s_mov_b64 exec, -1
    ds_read_b128 v[128:131], v47 offset:0
    ds_read_b128 v[132:135], v47 offset:32
    ds_read_b128 v[136:139], v47 offset:64
    ds_read_b128 v[140:143], v47 offset:96
    s_cmp_eq_u32 s60, 2
    s_cbranch_scc1 Lsff_23
    s_cmp_eq_u32 s60, 1
    s_cbranch_scc0 Lsfq_24
    s_waitcnt vmcnt(0)
    v_readfirstlane_b32 s62, v196
    s_nop 3
    s_cmp_eq_u32 s62, 1
    s_cbranch_scc0 Lsfq_24
    buffer_load_dwordx2 v[192:193], v197, s[16:19], s61 offen sc1
    buffer_load_dwordx2 v[194:195], v197, s[16:19], s61 offen offset:256 sc1
    s_branch Lsff_23
Lsfq_24:
    v_mov_b32 v2, s63
    v_mov_b32 v3, 1
    s_mov_b32 s52, 40000
Lpoll_26:
    buffer_load_dword v1, v2, s[24:27], 0 offen sc1
    s_waitcnt vmcnt(0)
    v_cmp_le_u32 vcc, v3, v1
    s_cmp_eq_u64 vcc, -1
    s_cbranch_scc1 Lpolld_27
    s_sleep 1
    s_sub_u32 s52, s52, 1
    s_cmp_lg_u32 s52, 0
    s_cbranch_scc1 Lpoll_26
Lpolld_27:
    buffer_load_dwordx2 v[192:193], v197, s[16:19], s61 offen sc1
    buffer_load_dwordx2 v[194:195], v197, s[16:19], s61 offen offset:256 sc1
Lsff_23:
    s_waitcnt vmcnt(0)
    v_mul_f32 v193, s64, v193
    v_mul_f32 v195, s64, v195
    s_waitcnt lgkmcnt(0)
    v_pk_fma_f32 v[64:65], v[128:129], v[192:193], v[64:65] op_sel_hi:[1,0,1]
    v_pk_fma_f32 v[66:67], v[130:131], v[192:193], v[66:67] op_sel_hi:[1,0,1]
    v_pk_mul_f32 v[64:65], v[64:65], v[192:193] op_sel:[0,1] op_sel_hi:[1,1]
    v_pk_mul_f32 v[66:67], v[66:67], v[192:193] op_sel:[0,1] op_sel_hi:[1,1]
    v_cvt_pk_bf16_f32 v164, v64, v65
    v_cvt_pk_bf16_f32 v165, v66, v67
    v_pk_fma_f32 v[68:69], v[132:133], v[192:193], v[68:69] op_sel_hi:[1,0,1]
    v_pk_fma_f32 v[70:71], v[134:135], v[192:193], v[70:71] op_sel_hi:[1,0,1]
    v_pk_mul_f32 v[68:69], v[68:69], v[192:193] op_sel:[0,1] op_sel_hi:[1,1]
    v_pk_mul_f32 v[70:71], v[70:71], v[192:193] op_sel:[0,1] op_sel_hi:[1,1]
    v_cvt_pk_bf16_f32 v166, v68, v69
    v_cvt_pk_bf16_f32 v167, v70, v71
    s_nop 0
    v_permlane32_swap_b32 v164, v166
    v_permlane32_swap_b32 v165, v167
    s_add_u32 s57, s65, 0
    buffer_store_dwordx4 v[164:167], v49, s[16:19], s57 offen sc1
    v_pk_fma_f32 v[72:73], v[136:137], v[192:193], v[72:73] op_sel_hi:[1,0,1]
    v_pk_fma_f32 v[74:75], v[138:139], v[192:193], v[74:75] op_sel_hi:[1,0,1]
    v_pk_mul_f32 v[72:73], v[72:73], v[192:193] op_sel:[0,1] op_sel_hi:[1,1]
    v_pk_mul_f32 v[74:75], v[74:75], v[192:193] op_sel:[0,1] op_sel_hi:[1,1]
    v_cvt_pk_bf16_f32 v168, v72, v73
    v_cvt_pk_bf16_f32 v169, v74, v75
    v_pk_fma_f32 v[76:77], v[140:141], v[192:193], v[76:77] op_sel_hi:[1,0,1]
    v_pk_fma_f32 v[78:79], v[142:143], v[192:193], v[78:79] op_sel_hi:[1,0,1]
    v_pk_mul_f32 v[76:77], v[76:77], v[192:193] op_sel:[0,1] op_sel_hi:[1,1]
    v_pk_mul_f32 v[78:79], v[78:79], v[192:193] op_sel:[0,1] op_sel_hi:[1,1]
    v_cvt_pk_bf16_f32 v170, v76, v77
    v_cvt_pk_bf16_f32 v171, v78, v79
    s_nop 0
    v_permlane32_swap_b32 v168, v170
    v_permlane32_swap_b32 v169, v171
    s_add_u32 s57, s65, 65536
    buffer_store_dwordx4 v[168:171], v49, s[16:19], s57 offen sc1
    s_barrier
    ds_read_b128 v[144:147], v48 offset:0
    ds_read_b128 v[148:151], v48 offset:32
    ds_read_b128 v[152:155], v48 offset:64
    ds_read_b128 v[156:159], v48 offset:96
    v_pk_fma_f32 v[80:81], v[128:129], v[194:195], v[80:81] op_sel_hi:[1,0,1]
    v_pk_fma_f32 v[82:83], v[130:131], v[194:195], v[82:83] op_sel_hi:[1,0,1]
    v_pk_mul_f32 v[80:81], v[80:81], v[194:195] op_sel:[0,1] op_sel_hi:[1,1]
    v_pk_mul_f32 v[82:83], v[82:83], v[194:195] op_sel:[0,1] op_sel_hi:[1,1]
    v_cvt_pk_bf16_f32 v172, v80, v81
    v_cvt_pk_bf16_f32 v173, v82, v83
    v_pk_fma_f32 v[84:85], v[132:133], v[194:195], v[84:85] op_sel_hi:[1,0,1]
    v_pk_fma_f32 v[86:87], v[134:135], v[194:195], v[86:87] op_sel_hi:[1,0,1]
    v_pk_mul_f32 v[84:85], v[84:85], v[194:195] op_sel:[0,1] op_sel_hi:[1,1]
    v_pk_mul_f32 v[86:87], v[86:87], v[194:195] op_sel:[0,1] op_sel_hi:[1,1]
    v_cvt_pk_bf16_f32 v174, v84, v85
    v_cvt_pk_bf16_f32 v175, v86, v87
    s_nop 0
    v_permlane32_swap_b32 v172, v174
    v_permlane32_swap_b32 v173, v175
    s_add_u32 s57, s65, 512
    buffer_store_dwordx4 v[172:175], v49, s[16:19], s57 offen sc1
    v_pk_fma_f32 v[88:89], v[136:137], v[194:195], v[88:89] op_sel_hi:[1,0,1]
    v_pk_fma_f32 v[90:91], v[138:139], v[194:195], v[90:91] op_sel_hi:[1,0,1]
    v_pk_mul_f32 v[88:89], v[88:89], v[194:195] op_sel:[0,1] op_sel_hi:[1,1]
    v_pk_mul_f32 v[90:91], v[90:91], v[194:195] op_sel:[0,1] op_sel_hi:[1,1]
    v_cvt_pk_bf16_f32 v176, v88, v89
    v_cvt_pk_bf16_f32 v177, v90, v91
    v_pk_fma_f32 v[92:93], v[140:141], v[194:195], v[92:93] op_sel_hi:[1,0,1]
    v_pk_fma_f32 v[94:95], v[142:143], v[194:195], v[94:95] op_sel_hi:[1,0,1]
    v_pk_mul_f32 v[92:93], v[92:93], v[194:195] op_sel:[0,1] op_sel_hi:[1,1]
    v_pk_mul_f32 v[94:95], v[94:95], v[194:195] op_sel:[0,1] op_sel_hi:[1,1]
    v_cvt_pk_bf16_f32 v178, v92, v93
    v_cvt_pk_bf16_f32 v179, v94, v95
    s_nop 0
    v_permlane32_swap_b32 v176, v178
    v_permlane32_swap_b32 v177, v179
    s_add_u32 s57, s65, 66048
    buffer_store_dwordx4 v[176:179], v49, s[16:19], s57 offen sc1
    s_waitcnt lgkmcnt(0)
    v_pk_fma_f32 v[96:97], v[144:145], v[192:193], v[96:97] op_sel_hi:[1,0,1]
    v_pk_fma_f32 v[98:99], v[146:147], v[192:193], v[98:99] op_sel_hi:[1,0,1]
    v_pk_mul_f32 v[96:97], v[96:97], v[192:193] op_sel:[0,1] op_sel_hi:[1,1]
    v_pk_mul_f32 v[98:99], v[98:99], v[192:193] op_sel:[0,1] op_sel_hi:[1,1]
    v_cvt_pk_bf16_f32 v164, v96, v97
    v_cvt_pk_bf16_f32 v165, v98, v99
    v_pk_fma_f32 v[100:101], v[148:149], v[192:193], v[100:101] op_sel_hi:[1,0,1]
    v_pk_fma_f32 v[102:103], v[150:151], v[192:193], v[102:103] op_sel_hi:[1,0,1]
    v_pk_mul_f32 v[100:101], v[100:101], v[192:193] op_sel:[0,1] op_sel_hi:[1,1]
    v_pk_mul_f32 v[102:103], v[102:103], v[192:193] op_sel:[0,1] op_sel_hi:[1,1]
    v_cvt_pk_bf16_f32 v166, v100, v101
    v_cvt_pk_bf16_f32 v167, v102, v103
    s_nop 0
    v_permlane32_swap_b32 v164, v166
    v_permlane32_swap_b32 v165, v167
    s_add_u32 s57, s66, 0
    buffer_store_dwordx4 v[164:167], v49, s[16:19], s57 offen sc1
    v_pk_fma_f32 v[104:105], v[152:153], v[192:193], v[104:105] op_sel_hi:[1,0,1]
    v_pk_fma_f32 v[106:107], v[154:155], v[192:193], v[106:107] op_sel_hi:[1,0,1]
    v_pk_mul_f32 v[104:105], v[104:105], v[192:193] op_sel:[0,1] op_sel_hi:[1,1]
    v_pk_mul_f32 v[106:107], v[106:107], v[192:193] op_sel:[0,1] op_sel_hi:[1,1]
    v_cvt_pk_bf16_f32 v168, v104, v105
    v_cvt_pk_bf16_f32 v169, v106, v107
    v_pk_fma_f32 v[108:109], v[156:157], v[192:193], v[108:109] op_sel_hi:[1,0,1]
    v_pk_fma_f32 v[110:111], v[158:159], v[192:193], v[110:111] op_sel_hi:[1,0,1]
    v_pk_mul_f32 v[108:109], v[108:109], v[192:193] op_sel:[0,1] op_sel_hi:[1,1]
    v_pk_mul_f32 v[110:111], v[110:111], v[192:193] op_sel:[0,1] op_sel_hi:[1,1]
    v_cvt_pk_bf16_f32 v170, v108, v109
    v_cvt_pk_bf16_f32 v171, v110, v111
    s_nop 0
    v_permlane32_swap_b32 v168, v170
    v_permlane32_swap_b32 v169, v171
    s_add_u32 s57, s66, 65536
    buffer_store_dwordx4 v[168:171], v49, s[16:19], s57 offen sc1
    v_pk_fma_f32 v[112:113], v[144:145], v[194:195], v[112:113] op_sel_hi:[1,0,1]
    v_pk_fma_f32 v[114:115], v[146:147], v[194:195], v[114:115] op_sel_hi:[1,0,1]
    v_pk_mul_f32 v[112:113], v[112:113], v[194:195] op_sel:[0,1] op_sel_hi:[1,1]
    v_pk_mul_f32 v[114:115], v[114:115], v[194:195] op_sel:[0,1] op_sel_hi:[1,1]
    v_cvt_pk_bf16_f32 v172, v112, v113
    v_cvt_pk_bf16_f32 v173, v114, v115
    v_pk_fma_f32 v[116:117], v[148:149], v[194:195], v[116:117] op_sel_hi:[1,0,1]
    v_pk_fma_f32 v[118:119], v[150:151], v[194:195], v[118:119] op_sel_hi:[1,0,1]
    v_pk_mul_f32 v[116:117], v[116:117], v[194:195] op_sel:[0,1] op_sel_hi:[1,1]
    v_pk_mul_f32 v[118:119], v[118:119], v[194:195] op_sel:[0,1] op_sel_hi:[1,1]
    v_cvt_pk_bf16_f32 v174, v116, v117
    v_cvt_pk_bf16_f32 v175, v118, v119
    s_nop 0
    v_permlane32_swap_b32 v172, v174
    v_permlane32_swap_b32 v173, v175
    s_add_u32 s57, s66, 512
    buffer_store_dwordx4 v[172:175], v49, s[16:19], s57 offen sc1
    v_pk_fma_f32 v[120:121], v[152:153], v[194:195], v[120:121] op_sel_hi:[1,0,1]
    v_pk_fma_f32 v[122:123], v[154:155], v[194:195], v[122:123] op_sel_hi:[1,0,1]
    v_pk_mul_f32 v[120:121], v[120:121], v[194:195] op_sel:[0,1] op_sel_hi:[1,1]
    v_pk_mul_f32 v[122:123], v[122:123], v[194:195] op_sel:[0,1] op_sel_hi:[1,1]
    v_cvt_pk_bf16_f32 v176, v120, v121
    v_cvt_pk_bf16_f32 v177, v122, v123
    v_pk_fma_f32 v[124:125], v[156:157], v[194:195], v[124:125] op_sel_hi:[1,0,1]
    v_pk_fma_f32 v[126:127], v[158:159], v[194:195], v[126:127] op_sel_hi:[1,0,1]
    v_pk_mul_f32 v[124:125], v[124:125], v[194:195] op_sel:[0,1] op_sel_hi:[1,1]
    v_pk_mul_f32 v[126:127], v[126:127], v[194:195] op_sel:[0,1] op_sel_hi:[1,1]
    v_cvt_pk_bf16_f32 v178, v124, v125
    v_cvt_pk_bf16_f32 v179, v126, v127
    s_nop 0
    v_permlane32_swap_b32 v176, v178
    v_permlane32_swap_b32 v177, v179
    s_add_u32 s57, s66, 66048
    buffer_store_dwordx4 v[176:179], v49, s[16:19], s57 offen sc1
    s_waitcnt vmcnt(0)
    s_barrier
    s_branch Lp2_4
Lp1aux_2:
    s_waitcnt lgkmcnt(0)
    s_mov_b32 s4, s32
    s_and_b32 s5, s33, 0xffff
    s_mov_b32 s6, 2621440
    s_mov_b32 s7, 0x20000
    s_mov_b32 s8, s34
    s_and_b32 s9, s35, 0xffff
    s_mov_b32 s10, 2457600
    s_mov_b32 s11, 0x20000
    s_mov_b32 s16, s50
    s_and_b32 s17, s51, 0xffff
    s_mov_b32 s18, 34603008
    s_mov_b32 s19, 0x20000
    s_mov_b32 s24, s48
    s_and_b32 s25, s49, 0xffff
    s_mov_b32 s26, 256
    s_mov_b32 s27, 0x20000
    s_mov_b32 s20, s46
    s_and_b32 s21, s47, 0xffff
    s_mov_b32 s22, 2621440
    s_mov_b32 s23, 0x20000
    v_lshrrev_b32 v1, 3, v0
    v_mul_u32_u24 v2, 1280, v1
    v_and_b32 v3, 7, v0
    v_lshl_add_u32 v2, v3, 4, v2
    s_lshl_b32 s52, s28, 7
    s_lshl_b32 s53, s30, 4
    s_add_u32 s54, s52, s53
    s_mul_i32 s52, s54, 1280
    buffer_load_dwordx4 v[64:67], v2, s[4:7], s52 offen offset:0
    buffer_load_dwordx4 v[68:71], v2, s[4:7], s52 offen offset:128
    buffer_load_dwordx4 v[72:75], v2, s[4:7], s52 offen offset:256
    buffer_load_dwordx4 v[76:79], v2, s[4:7], s52 offen offset:384
    buffer_load_dwordx4 v[80:83], v2, s[4:7], s52 offen offset:512
    buffer_load_dwordx4 v[84:87], v2, s[4:7], s52 offen offset:640
    buffer_load_dwordx4 v[88:91], v2, s[4:7], s52 offen offset:768
    buffer_load_dwordx4 v[92:95], v2, s[4:7], s52 offen offset:896
    buffer_load_dwordx4 v[96:99], v2, s[4:7], s52 offen offset:1024
    buffer_load_dwordx4 v[100:103], v2, s[4:7], s52 offen offset:1152
    s_add_u32 s52, s52, 10240
    buffer_load_dwordx4 v[104:107], v2, s[4:7], s52 offen offset:0
    buffer_load_dwordx4 v[108:111], v2, s[4:7], s52 offen offset:128
    buffer_load_dwordx4 v[112:115], v2, s[4:7], s52 offen offset:256
    buffer_load_dwordx4 v[116:119], v2, s[4:7], s52 offen offset:384
    buffer_load_dwordx4 v[120:123], v2, s[4:7], s52 offen offset:512
    buffer_load_dwordx4 v[124:127], v2, s[4:7], s52 offen offset:640
    buffer_load_dwordx4 v[128:131], v2, s[4:7], s52 offen offset:768
    buffer_load_dwordx4 v[132:135], v2, s[4:7], s52 offen offset:896
    buffer_load_dwordx4 v[136:139], v2, s[4:7], s52 offen offset:1024
    buffer_load_dwordx4 v[140:143], v2, s[4:7], s52 offen offset:1152
    v_mov_b32 v20, 0
    v_mov_b32 v21, 0
    v_mov_b32 v22, 0
    v_mov_b32 v23, 0
    v_mov_b32 v24, 0
    v_mov_b32 v25, 0
    v_mov_b32 v26, 0
    v_mov_b32 v27, 0
    v_mov_b32 v28, 0
    v_mov_b32 v29, 0
    v_mov_b32 v30, 0
    v_mov_b32 v31, 0
    v_mov_b32 v32, 0
    v_mov_b32 v33, 0
    v_mov_b32 v34, 0
    v_mov_b32 v35, 0
    v_mov_b32 v47, 0x3f803f80
    s_waitcnt vmcnt(18)
    v_dot2c_f32_bf16 v20, v64, v47
    v_dot2c_f32_bf16 v24, v64, v64
    v_dot2c_f32_bf16 v21, v65, v47
    v_dot2c_f32_bf16 v25, v65, v65
    v_dot2c_f32_bf16 v22, v66, v47
    v_dot2c_f32_bf16 v26, v66, v66
    v_dot2c_f32_bf16 v23, v67, v47
    v_dot2c_f32_bf16 v27, v67, v67
    v_dot2c_f32_bf16 v20, v68, v47
    v_dot2c_f32_bf16 v24, v68, v68
    v_dot2c_f32_bf16 v21, v69, v47
    v_dot2c_f32_bf16 v25, v69, v69
    v_dot2c_f32_bf16 v22, v70, v47
    v_dot2c_f32_bf16 v26, v70, v70
    v_dot2c_f32_bf16 v23, v71, v47
    v_dot2c_f32_bf16 v27, v71, v71
    s_waitcnt vmcnt(16)
    v_dot2c_f32_bf16 v20, v72, v47
    v_dot2c_f32_bf16 v24, v72, v72
    v_dot2c_f32_bf16 v21, v73, v47
    v_dot2c_f32_bf16 v25, v73, v73
    v_dot2c_f32_bf16 v22, v74, v47
    v_dot2c_f32_bf16 v26, v74, v74
    v_dot2c_f32_bf16 v23, v75, v47
    v_dot2c_f32_bf16 v27, v75, v75
    v_dot2c_f32_bf16 v20, v76, v47
    v_dot2c_f32_bf16 v24, v76, v76
    v_dot2c_f32_bf16 v21, v77, v47
    v_dot2c_f32_bf16 v25, v77, v77
    v_dot2c_f32_bf16 v22, v78, v47
    v_dot2c_f32_bf16 v26, v78, v78
    v_dot2c_f32_bf16 v23, v79, v47
    v_dot2c_f32_bf16 v27, v79, v79
    s_waitcnt vmcnt(14)
    v_dot2c_f32_bf16 v20, v80, v47
    v_dot2c_f32_bf16 v24, v80, v80
    v_dot2c_f32_bf16 v21, v81, v47
    v_dot2c_f32_bf16 v25, v81, v81
    v_dot2c_f32_bf16 v22, v82, v47
    v_dot2c_f32_bf16 v26, v82, v82
    v_dot2c_f32_bf16 v23, v83, v47
    v_dot2c_f32_bf16 v27, v83, v83
    v_dot2c_f32_bf16 v20, v84, v47
    v_dot2c_f32_bf16 v24, v84, v84
    v_dot2c_f32_bf16 v21, v85, v47
    v_dot2c_f32_bf16 v25, v85, v85
    v_dot2c_f32_bf16 v22, v86, v47
    v_dot2c_f32_bf16 v26, v86, v86
    v_dot2c_f32_bf16 v23, v87, v47
    v_dot2c_f32_bf16 v27, v87, v87
    s_waitcnt vmcnt(12)
    v_dot2c_f32_bf16 v20, v88, v47
    v_dot2c_f32_bf16 v24, v88, v88
    v_dot2c_f32_bf16 v21, v89, v47
    v_dot2c_f32_bf16 v25, v89, v89
    v_dot2c_f32_bf16 v22, v90, v47
    v_dot2c_f32_bf16 v26, v90, v90
    v_dot2c_f32_bf16 v23, v91, v47
    v_dot2c_f32_bf16 v27, v91, v91
    v_dot2c_f32_bf16 v20, v92, v47
    v_dot2c_f32_bf16 v24, v92, v92
    v_dot2c_f32_bf16 v21, v93, v47
    v_dot2c_f32_bf16 v25, v93, v93
    v_dot2c_f32_bf16 v22, v94, v47
    v_dot2c_f32_bf16 v26, v94, v94
    v_dot2c_f32_bf16 v23, v95, v47
    v_dot2c_f32_bf16 v27, v95, v95
    s_waitcnt vmcnt(10)
    v_dot2c_f32_bf16 v20, v96, v47
    v_dot2c_f32_bf16 v24, v96, v96
    v_dot2c_f32_bf16 v21, v97, v47
    v_dot2c_f32_bf16 v25, v97, v97
    v_dot2c_f32_bf16 v22, v98, v47
    v_dot2c_f32_bf16 v26, v98, v98
    v_dot2c_f32_bf16 v23, v99, v47
    v_dot2c_f32_bf16 v27, v99, v99
    v_dot2c_f32_bf16 v20, v100, v47
    v_dot2c_f32_bf16 v24, v100, v100
    v_dot2c_f32_bf16 v21, v101, v47
    v_dot2c_f32_bf16 v25, v101, v101
    v_dot2c_f32_bf16 v22, v102, v47
    v_dot2c_f32_bf16 v26, v102, v102
    v_dot2c_f32_bf16 v23, v103, v47
    v_dot2c_f32_bf16 v27, v103, v103
    s_waitcnt vmcnt(8)
    v_dot2c_f32_bf16 v28, v104, v47
    v_dot2c_f32_bf16 v32, v104, v104
    v_dot2c_f32_bf16 v29, v105, v47
    v_dot2c_f32_bf16 v33, v105, v105
    v_dot2c_f32_bf16 v30, v106, v47
    v_dot2c_f32_bf16 v34, v106, v106
    v_dot2c_f32_bf16 v31, v107, v47
    v_dot2c_f32_bf16 v35, v107, v107
    v_dot2c_f32_bf16 v28, v108, v47
    v_dot2c_f32_bf16 v32, v108, v108
    v_dot2c_f32_bf16 v29, v109, v47
    v_dot2c_f32_bf16 v33, v109, v109
    v_dot2c_f32_bf16 v30, v110, v47
    v_dot2c_f32_bf16 v34, v110, v110
    v_dot2c_f32_bf16 v31, v111, v47
    v_dot2c_f32_bf16 v35, v111, v111
    s_waitcnt vmcnt(6)
    v_dot2c_f32_bf16 v28, v112, v47
    v_dot2c_f32_bf16 v32, v112, v112
    v_dot2c_f32_bf16 v29, v113, v47
    v_dot2c_f32_bf16 v33, v113, v113
    v_dot2c_f32_bf16 v30, v114, v47
    v_dot2c_f32_bf16 v34, v114, v114
    v_dot2c_f32_bf16 v31, v115, v47
    v_dot2c_f32_bf16 v35, v115, v115
    v_dot2c_f32_bf16 v28, v116, v47
    v_dot2c_f32_bf16 v32, v116, v116
    v_dot2c_f32_bf16 v29, v117, v47
    v_dot2c_f32_bf16 v33, v117, v117
    v_dot2c_f32_bf16 v30, v118, v47
    v_dot2c_f32_bf16 v34, v118, v118
    v_dot2c_f32_bf16 v31, v119, v47
    v_dot2c_f32_bf16 v35, v119, v119
    s_waitcnt vmcnt(4)
    v_dot2c_f32_bf16 v28, v120, v47
    v_dot2c_f32_bf16 v32, v120, v120
    v_dot2c_f32_bf16 v29, v121, v47
    v_dot2c_f32_bf16 v33, v121, v121
    v_dot2c_f32_bf16 v30, v122, v47
    v_dot2c_f32_bf16 v34, v122, v122
    v_dot2c_f32_bf16 v31, v123, v47
    v_dot2c_f32_bf16 v35, v123, v123
    v_dot2c_f32_bf16 v28, v124, v47
    v_dot2c_f32_bf16 v32, v124, v124
    v_dot2c_f32_bf16 v29, v125, v47
    v_dot2c_f32_bf16 v33, v125, v125
    v_dot2c_f32_bf16 v30, v126, v47
    v_dot2c_f32_bf16 v34, v126, v126
    v_dot2c_f32_bf16 v31, v127, v47
    v_dot2c_f32_bf16 v35, v127, v127
    s_waitcnt vmcnt(2)
    v_dot2c_f32_bf16 v28, v128, v47
    v_dot2c_f32_bf16 v32, v128, v128
    v_dot2c_f32_bf16 v29, v129, v47
    v_dot2c_f32_bf16 v33, v129, v129
    v_dot2c_f32_bf16 v30, v130, v47
    v_dot2c_f32_bf16 v34, v130, v130
    v_dot2c_f32_bf16 v31, v131, v47
    v_dot2c_f32_bf16 v35, v131, v131
    v_dot2c_f32_bf16 v28, v132, v47
    v_dot2c_f32_bf16 v32, v132, v132
    v_dot2c_f32_bf16 v29, v133, v47
    v_dot2c_f32_bf16 v33, v133, v133
    v_dot2c_f32_bf16 v30, v134, v47
    v_dot2c_f32_bf16 v34, v134, v134
    v_dot2c_f32_bf16 v31, v135, v47
    v_dot2c_f32_bf16 v35, v135, v135
    s_waitcnt vmcnt(0)
    v_dot2c_f32_bf16 v28, v136, v47
    v_dot2c_f32_bf16 v32, v136, v136
    v_dot2c_f32_bf16 v29, v137, v47
    v_dot2c_f32_bf16 v33, v137, v137
    v_dot2c_f32_bf16 v30, v138, v47
    v_dot2c_f32_bf16 v34, v138, v138
    v_dot2c_f32_bf16 v31, v139, v47
    v_dot2c_f32_bf16 v35, v139, v139
    v_dot2c_f32_bf16 v28, v140, v47
    v_dot2c_f32_bf16 v32, v140, v140
    v_dot2c_f32_bf16 v29, v141, v47
    v_dot2c_f32_bf16 v33, v141, v141
    v_dot2c_f32_bf16 v30, v142, v47
    v_dot2c_f32_bf16 v34, v142, v142
    v_dot2c_f32_bf16 v31, v143, v47
    v_dot2c_f32_bf16 v35, v143, v143
    v_pk_add_f32 v[20:21], v[20:21], v[22:23]
    v_pk_add_f32 v[24:25], v[24:25], v[26:27]
    v_pk_add_f32 v[28:29], v[28:29], v[30:31]
    v_pk_add_f32 v[32:33], v[32:33], v[34:35]
    v_add_f32 v20, v20, v21
    v_add_f32 v24, v24, v25
    v_add_f32 v28, v28, v29
    v_add_f32 v32, v32, v33
    v_add_f32_dpp v20, v20, v20 quad_perm:[1,0,3,2] row_mask:0xf bank_mask:0xf
    v_add_f32_dpp v24, v24, v24 quad_perm:[1,0,3,2] row_mask:0xf bank_mask:0xf
    v_add_f32_dpp v28, v28, v28 quad_perm:[1,0,3,2] row_mask:0xf bank_mask:0xf
    v_add_f32_dpp v32, v32, v32 quad_perm:[1,0,3,2] row_mask:0xf bank_mask:0xf
    v_add_f32_dpp v20, v20, v20 quad_perm:[2,3,0,1] row_mask:0xf bank_mask:0xf
    v_add_f32_dpp v24, v24, v24 quad_perm:[2,3,0,1] row_mask:0xf bank_mask:0xf
    v_add_f32_dpp v28, v28, v28 quad_perm:[2,3,0,1] row_mask:0xf bank_mask:0xf
    v_add_f32_dpp v32, v32, v32 quad_perm:[2,3,0,1] row_mask:0xf bank_mask:0xf
    v_add_f32_dpp v20, v20, v20 row_half_mirror row_mask:0xf bank_mask:0xf
    v_add_f32_dpp v24, v24, v24 row_half_mirror row_mask:0xf bank_mask:0xf
    v_add_f32_dpp v28, v28, v28 row_half_mirror row_mask:0xf bank_mask:0xf
    v_add_f32_dpp v32, v32, v32 row_half_mirror row_mask:0xf bank_mask:0xf
    s_mov_b32 s52, 0x3acccccd
    s_mov_b32 s53, 0x3727c5ac
    v_mul_f32 v20, s52, v20
    v_mul_f32 v24, s52, v24
    v_fma_f32 v24, -v20, v20, v24
    v_max_f32 v24, 0, v24
    v_add_f32 v24, s53, v24
    v_rsq_f32 v21, v24
    v_sub_f32 v20, 0, v20
    v_mul_f32 v28, s52, v28
    v_mul_f32 v32, s52, v32
    v_fma_f32 v32, -v28, v28, v32
    v_max_f32 v32, 0, v32
    v_add_f32 v32, s53, v32
    v_rsq_f32 v29, v32
    v_sub_f32 v28, 0, v28
    v_lshlrev_b32 v1, 3, v1
    s_lshl_b32 s54, s54, 3
    s_add_u32 s54, s54, 393216
    s_mov_b32 exec_lo, 0x01010101
    s_mov_b32 exec_hi, 0x01010101
    buffer_store_dwordx2 v[20:21], v1, s[16:19], s54 offen sc1
    buffer_store_dwordx2 v[28:29], v1, s[16:19], s54 offen offset:64 sc1
    s_mov_b64 exec, -1
    s_waitcnt vmcnt(0)
    s_barrier
    s_cmp_lg_u32 s30, 0
    s_cbranch_scc1 Lnofl_28
    s_lshl_b32 s52, s28, 2
    s_add_u32 s52, s52, 64
    v_mov_b32 v2, 1
    s_mov_b64 exec, 1
    buffer_store_dword v2, off, s[24:27], s52 sc1
    s_mov_b64 exec, -1
Lnofl_28:
    s_mov_b32 s8, s36
    s_and_b32 s9, s37, 0xffff
    s_mov_b32 s10, 819200
    s_mov_b32 s11, 0x20000
    s_lshr_b32 s54, s28, 1
    s_and_b32 s55, s28, 1
    s_mul_i32 s55, s55, 320
    s_mul_i32 s56, s54, 102400
    s_mul_i32 s59, s55, 160
    s_add_u32 s56, s56, s59
    s_add_u32 s56, s56, 1048576
    s_lshl_b32 s52, s30, 6
    v_add_u32 v1, s52, v0
    s_mul_i32 s53, s54, 160
    s_mov_b32 s57, 52429
    s_mov_b32 s58, 3200
    v_add_u32 v2, 0, v1
    v_mul_lo_u32 v3, v2, s57
    v_lshrrev_b32 v3, 19, v3
    v_mul_u32_u24 v4, 10, v3
    v_sub_u32 v4, v2, v4
    v_add_u32 v3, s55, v3
    v_and_b32 v5, 0xfffffff3, v3
    v_and_b32 v6, 4, v3
    v_lshl_or_b32 v5, v6, 1, v5
    v_and_b32 v6, 8, v3
    v_lshrrev_b32 v6, 1, v6
    v_or_b32 v5, v5, v6
    v_mul_u32_u24 v5, 1280, v5
    v_lshl_add_u32 v5, v4, 4, v5
    v_add_u32 v5, s53, v5
    v_lshlrev_b32 v10, 4, v2
    buffer_load_dwordx4 v[24:27], v5, s[8:11], 0 offen
    v_add_u32 v2, 512, v1
    v_mul_lo_u32 v3, v2, s57
    v_lshrrev_b32 v3, 19, v3
    v_mul_u32_u24 v4, 10, v3
    v_sub_u32 v4, v2, v4
    v_add_u32 v3, s55, v3
    v_and_b32 v5, 0xfffffff3, v3
    v_and_b32 v6, 4, v3
    v_lshl_or_b32 v5, v6, 1, v5
    v_and_b32 v6, 8, v3
    v_lshrrev_b32 v6, 1, v6
    v_or_b32 v5, v5, v6
    v_mul_u32_u24 v5, 1280, v5
    v_lshl_add_u32 v5, v4, 4, v5
    v_add_u32 v5, s53, v5
    v_lshlrev_b32 v11, 4, v2
    buffer_load_dwordx4 v[28:31], v5, s[8:11], 0 offen
    v_add_u32 v2, 1024, v1
    v_mul_lo_u32 v3, v2, s57
    v_lshrrev_b32 v3, 19, v3
    v_mul_u32_u24 v4, 10, v3
    v_sub_u32 v4, v2, v4
    v_add_u32 v3, s55, v3
    v_and_b32 v5, 0xfffffff3, v3
    v_and_b32 v6, 4, v3
    v_lshl_or_b32 v5, v6, 1, v5
    v_and_b32 v6, 8, v3
    v_lshrrev_b32 v6, 1, v6
    v_or_b32 v5, v5, v6
    v_mul_u32_u24 v5, 1280, v5
    v_lshl_add_u32 v5, v4, 4, v5
    v_add_u32 v5, s53, v5
    v_lshlrev_b32 v12, 4, v2
    buffer_load_dwordx4 v[32:35], v5, s[8:11], 0 offen
    v_add_u32 v2, 1536, v1
    v_mul_lo_u32 v3, v2, s57
    v_lshrrev_b32 v3, 19, v3
    v_mul_u32_u24 v4, 10, v3
    v_sub_u32 v4, v2, v4
    v_add_u32 v3, s55, v3
    v_and_b32 v5, 0xfffffff3, v3
    v_and_b32 v6, 4, v3
    v_lshl_or_b32 v5, v6, 1, v5
    v_and_b32 v6, 8, v3
    v_lshrrev_b32 v6, 1, v6
    v_or_b32 v5, v5, v6
    v_mul_u32_u24 v5, 1280, v5
    v_lshl_add_u32 v5, v4, 4, v5
    v_add_u32 v5, s53, v5
    v_lshlrev_b32 v13, 4, v2
    buffer_load_dwordx4 v[36:39], v5, s[8:11], 0 offen
    v_add_u32 v2, 2048, v1
    v_mul_lo_u32 v3, v2, s57
    v_lshrrev_b32 v3, 19, v3
    v_mul_u32_u24 v4, 10, v3
    v_sub_u32 v4, v2, v4
    v_add_u32 v3, s55, v3
    v_and_b32 v5, 0xfffffff3, v3
    v_and_b32 v6, 4, v3
    v_lshl_or_b32 v5, v6, 1, v5
    v_and_b32 v6, 8, v3
    v_lshrrev_b32 v6, 1, v6
    v_or_b32 v5, v5, v6
    v_mul_u32_u24 v5, 1280, v5
    v_lshl_add_u32 v5, v4, 4, v5
    v_add_u32 v5, s53, v5
    v_lshlrev_b32 v14, 4, v2
    buffer_load_dwordx4 v[40:43], v5, s[8:11], 0 offen
    v_add_u32 v2, 2560, v1
    v_mul_lo_u32 v3, v2, s57
    v_lshrrev_b32 v3, 19, v3
    v_mul_u32_u24 v4, 10, v3
    v_sub_u32 v4, v2, v4
    v_add_u32 v3, s55, v3
    v_and_b32 v5, 0xfffffff3, v3
    v_and_b32 v6, 4, v3
    v_lshl_or_b32 v5, v6, 1, v5
    v_and_b32 v6, 8, v3
    v_lshrrev_b32 v6, 1, v6
    v_or_b32 v5, v5, v6
    v_mul_u32_u24 v5, 1280, v5
    v_lshl_add_u32 v5, v4, 4, v5
    v_add_u32 v5, s53, v5
    v_lshlrev_b32 v15, 4, v2
    buffer_load_dwordx4 v[44:47], v5, s[8:11], 0 offen
    v_add_u32 v2, 3072, v1
    v_mul_lo_u32 v3, v2, s57
    v_lshrrev_b32 v3, 19, v3
    v_mul_u32_u24 v4, 10, v3
    v_sub_u32 v4, v2, v4
    v_add_u32 v3, s55, v3
    v_and_b32 v5, 0xfffffff3, v3
    v_and_b32 v6, 4, v3
    v_lshl_or_b32 v5, v6, 1, v5
    v_and_b32 v6, 8, v3
    v_lshrrev_b32 v6, 1, v6
    v_or_b32 v5, v5, v6
    v_mul_u32_u24 v5, 1280, v5
    v_lshl_add_u32 v5, v4, 4, v5
    v_add_u32 v5, s53, v5
    v_lshlrev_b32 v16, 4, v2
    v_cmp_gt_u32 vcc, s58, v2
    s_and_saveexec_b64 s[68:69], vcc
    buffer_load_dwordx4 v[48:51], v5, s[8:11], 0 offen
    s_mov_b64 exec, -1
    s_waitcnt vmcnt(0)
    buffer_store_dwordx4 v[24:27], v10, s[16:19], s56 offen sc1
    buffer_store_dwordx4 v[28:31], v11, s[16:19], s56 offen sc1
    buffer_store_dwordx4 v[32:35], v12, s[16:19], s56 offen sc1
    buffer_store_dwordx4 v[36:39], v13, s[16:19], s56 offen sc1
    buffer_store_dwordx4 v[40:43], v14, s[16:19], s56 offen sc1
    buffer_store_dwordx4 v[44:47], v15, s[16:19], s56 offen sc1
    v_cmp_gt_u32 vcc, s58, v2
    s_and_saveexec_b64 s[68:69], vcc
    buffer_store_dwordx4 v[48:51], v16, s[16:19], s56 offen sc1
    s_mov_b64 exec, -1
    s_waitcnt vmcnt(0)
    s_cmp_lg_u32 s30, 4
    s_cbranch_scc1 Lnoini_29
    v_and_b32 v2, 15, v0
    v_lshlrev_b32 v2, 2, v2
    v_mov_b32 v3, 1
    s_mov_b32 s52, 40000
Lpoll_30:
    buffer_load_dword v1, v2, s[24:27], 0 offen sc1
    s_waitcnt vmcnt(0)
    v_cmp_le_u32 vcc, v3, v1
    s_cmp_eq_u64 vcc, -1
    s_cbranch_scc1 Lpolld_31
    s_sleep 1
    s_sub_u32 s52, s52, 1
    s_cmp_lg_u32 s52, 0
    s_cbranch_scc1 Lpoll_30
Lpolld_31:
Lnoini_29:
    s_barrier
    s_cmp_lg_u32 s30, 4
    s_cbranch_scc1 Lnosig_32
    s_mov_b32 s52, 16384
    v_mov_b32 v1, 1
    s_mov_b64 exec, 1
    buffer_atomic_add v1, off, s[16:19], s52 sc1
    s_mov_b64 exec, -1
Lnosig_32:
Lp2_4:
    s_and_b32 s54, s30, 1
    s_lshr_b32 s55, s30, 1
    s_mul_i32 s56, s54, 3
    s_lshl_b32 s52, s30, 10
    s_add_u32 s52, s52, 61760
    v_lshlrev_b32 v1, 4, v0
    v_add_u32 v2, s52, v1
    v_mov_b32 v4, 0x3f803f80
    v_mov_b32 v5, 0x3f803f80
    v_mov_b32 v6, 0x3f803f80
    v_mov_b32 v7, 0x3f803f80
    ds_write_b128 v2, v[4:7]
    v_lshlrev_b32 v13, 4, v0
    s_lshl_b32 s52, s28, 7
    s_lshl_b32 s53, s30, 6
    s_add_u32 s52, s52, s53
    s_sub_u32 s52, s52, 256
    s_max_i32 s52, s52, 0
    s_lshl_b32 s52, s52, 4
    s_mul_i32 s53, s29, 163840
    s_add_u32 s52, s52, s53
    s_add_u32 s64, s52, 7864320
    s_lshl_b32 s65, s30, 10
    v_and_b32 v2, 31, v0
    v_lshrrev_b32 v3, 5, v0
    v_lshlrev_b32 v4, 4, v2
    v_lshl_add_u32 v5, v3, 15, v4
    s_lshl_b32 s52, s28, 7
    s_lshl_b32 s53, s55, 5
    s_add_u32 s52, s52, s53
    s_lshl_b32 s59, s52, 4
    s_mul_i32 s53, s29, 5
    s_add_u32 s57, s53, s56
    s_lshl_b32 s57, s57, 15
    s_add_u32 s57, s57, s59
    s_add_u32 s66, s57, 5242880
    s_add_u32 s57, s53, 2
    s_lshl_b32 s57, s57, 15
    s_add_u32 s57, s57, s59
    s_add_u32 s67, s57, 5242880
    s_lshl_b32 s52, s55, 9
    v_add_u32 v6, s52, v4
    v_add_u32 v7, s56, v3
    v_mul_u32_u24 v7, 6144, v7
    v_add_u32 v40, v7, v6
    v_add_u32 v41, 12288, v6
    v_lshrrev_b32 v6, 4, v0
    v_bfe_u32 v7, v0, 2, 2
    v_and_b32 v8, 3, v0
    v_lshl_add_u32 v9, v3, 2, v7
    v_lshlrev_b32 v9, 4, v9
    v_add_u32 v9, s52, v9
    v_lshrrev_b32 v10, 1, v8
    v_add_u32 v10, s56, v10
    v_mul_u32_u24 v10, 6208, v10
    v_and_b32 v11, 1, v8
    v_lshl_add_u32 v10, v11, 3, v10
    v_add_u32 v10, 30720, v10
    s_lshl_b32 s53, s54, 3
    s_add_u32 s53, s53, 43136
    s_xor_b32 s57, s54, 1
    s_lshl_b32 s57, s57, 7
    s_add_u32 s57, s57, 61760
    v_mov_b32 v11, s57
    v_mov_b32 v12, s53
    v_cmp_eq_u32 vcc, 0, v8
    s_nop 1
    v_cndmask_b32 v11, v11, v12, vcc
    v_and_b32 v12, 1, v6
    v_cmp_eq_u32 vcc, 0, v12
    s_nop 1
    v_cndmask_b32 v10, v11, v10, vcc
    v_add_u32 v42, v10, v9
    v_lshlrev_b32 v7, 2, v3
    v_sub_u32 v43, v2, v7
    s_cmp_eq_u32 s54, 0
    s_cselect_b32 s60, -1, 0
    s_mov_b32 s61, 0
    s_cselect_b32 s62, 0, -1
    s_mov_b32 s63, 0
    s_cmp_lg_u32 s30, 4
    s_cbranch_scc1 Lnopoll_33
    v_lshrrev_b32 v8, 4, v0
    v_bfe_u32 v2, v0, 1, 2
    v_min_u32 v2, 2, v2
    v_cmp_eq_u32 vcc, 0, v8
    s_nop 1
    v_cndmask_b32 v2, v2, 0, vcc
    v_sub_u32 v2, s28, v2
    v_max_i32 v2, 0, v2
    v_lshlrev_b32 v2, 6, v2
    v_mul_u32_u24 v9, 640, v8
    s_mul_i32 s52, s29, 40
    v_add_u32 v9, s52, v9
    v_and_b32 v3, 1, v0
    v_mul_u32_u24 v3, 39, v3
    v_add_u32 v9, v9, v3
    v_lshrrev_b32 v9, 7, v9
    v_add_u32 v2, v2, v9
    v_mul_u32_u24 v2, 128, v2
    v_add_u32 v2, 131072, v2
    v_mov_b32 v3, 1
    v_cmp_le_u32 vcc, 48, v0
    v_readfirstlane_b32 s52, v2
    s_nop 1
    v_mov_b32 v8, s52
    v_cndmask_b32 v2, v2, v8, vcc
    s_mov_b32 s52, 40000
Lpoll_34:
    buffer_load_dword v1, v2, s[16:19], 0 offen sc1
    s_waitcnt vmcnt(0)
    v_cmp_le_u32 vcc, v3, v1
    s_cmp_eq_u64 vcc, -1
    s_cbranch_scc1 Lpolld_35
    s_sleep 1
    s_sub_u32 s52, s52, 1
    s_cmp_lg_u32 s52, 0
    s_cbranch_scc1 Lpoll_34
Lpolld_35:
Lnopoll_33:
    s_waitcnt lgkmcnt(0)
    s_barrier
    s_cmp_ge_u32 s30, 6
    s_cbranch_scc1 Lnodma_36
    s_add_u32 m0, s65, 0
    s_nop 0
    buffer_load_dwordx4 v13, s[16:19], s64 offen sc1 lds
    s_add_u32 s64, s64, 32768
    s_add_u32 m0, s65, 6144
    s_nop 0
    buffer_load_dwordx4 v13, s[16:19], s64 offen sc1 lds
    s_add_u32 s64, s64, 32768
    s_add_u32 m0, s65, 12288
    s_nop 0
    buffer_load_dwordx4 v13, s[16:19], s64 offen sc1 lds
    s_add_u32 s64, s64, 32768
    s_add_u32 m0, s65, 18432
    s_nop 0
    buffer_load_dwordx4 v13, s[16:19], s64 offen sc1 lds
    s_add_u32 s64, s64, 32768
    s_add_u32 m0, s65, 24576
    s_nop 0
    buffer_load_dwordx4 v13, s[16:19], s64 offen sc1 lds
    s_add_u32 s64, s64, 32768
Lnodma_36:
    buffer_load_dwordx4 v[224:227], v5, s[16:19], s66 offen sc1
    buffer_load_dwordx4 v[228:231], v4, s[16:19], s67 offen sc1
    s_cmp_ge_u32 s30, 6
    s_cbranch_scc1 Lnodmv_37
    s_add_u32 s64, s64, 2457600
    s_add_u32 m0, s65, 30720
    s_nop 0
    buffer_load_dwordx4 v13, s[16:19], s64 offen sc1 lds
    s_add_u32 s64, s64, 32768
    s_add_u32 m0, s65, 36928
    s_nop 0
    buffer_load_dwordx4 v13, s[16:19], s64 offen sc1 lds
    s_add_u32 s64, s64, 32768
    s_add_u32 m0, s65, 43136
    s_nop 0
    buffer_load_dwordx4 v13, s[16:19], s64 offen sc1 lds
    s_add_u32 s64, s64, 32768
    s_add_u32 m0, s65, 49344
    s_nop 0
    buffer_load_dwordx4 v13, s[16:19], s64 offen sc1 lds
    s_add_u32 s64, s64, 32768
    s_add_u32 m0, s65, 55552
    s_nop 0
    buffer_load_dwordx4 v13, s[16:19], s64 offen sc1 lds
    v_cmp_gt_i32 s[64:65], 0, v43
    v_cmp_gt_i32 s[66:67], 1, v43
    v_cmp_gt_i32 s[68:69], 2, v43
    v_cmp_gt_i32 s[70:71], 3, v43
    v_cmp_gt_i32 s[76:77], 8, v43
    v_cmp_gt_i32 s[78:79], 9, v43
    v_cmp_gt_i32 s[80:81], 10, v43
    v_cmp_gt_i32 s[82:83], 11, v43
    v_cmp_gt_i32 s[84:85], 16, v43
    v_cmp_gt_i32 s[86:87], 17, v43
    v_cmp_gt_i32 s[88:89], 18, v43
    v_cmp_gt_i32 s[90:91], 19, v43
    v_cmp_gt_i32 s[92:93], 24, v43
    v_cmp_gt_i32 s[94:95], 25, v43
    v_cmp_gt_i32 s[96:97], 26, v43
    v_cmp_gt_i32 s[98:99], 27, v43
    v_mov_b32 v104, 0xffff0000
    v_cndmask_b32 v96, 0, v104, s[66:67]
    v_cndmask_b32 v97, 0, v104, s[70:71]
    v_cndmask_b32 v98, 0, v104, s[78:79]
    v_cndmask_b32 v99, 0, v104, s[82:83]
    v_cndmask_b32 v100, 0, v104, s[86:87]
    v_cndmask_b32 v101, 0, v104, s[90:91]
    v_cndmask_b32 v102, 0, v104, s[94:95]
    v_cndmask_b32 v103, 0, v104, s[98:99]
    v_cndmask_b32 v96, v96, -1, s[64:65]
    v_cndmask_b32 v97, v97, -1, s[68:69]
    v_cndmask_b32 v98, v98, -1, s[76:77]
    v_cndmask_b32 v99, v99, -1, s[80:81]
    v_cndmask_b32 v100, v100, -1, s[84:85]
    v_cndmask_b32 v101, v101, -1, s[88:89]
    v_cndmask_b32 v102, v102, -1, s[92:93]
    v_cndmask_b32 v103, v103, -1, s[96:97]
    s_waitcnt vmcnt(5)
    s_branch Lkvw_38
Lnodmv_37:
    v_cmp_gt_i32 s[64:65], 0, v43
    v_cmp_gt_i32 s[66:67], 1, v43
    v_cmp_gt_i32 s[68:69], 2, v43
    v_cmp_gt_i32 s[70:71], 3, v43
    v_cmp_gt_i32 s[76:77], 8, v43
    v_cmp_gt_i32 s[78:79], 9, v43
    v_cmp_gt_i32 s[80:81], 10, v43
    v_cmp_gt_i32 s[82:83], 11, v43
    v_cmp_gt_i32 s[84:85], 16, v43
    v_cmp_gt_i32 s[86:87], 17, v43
    v_cmp_gt_i32 s[88:89], 18, v43
    v_cmp_gt_i32 s[90:91], 19, v43
    v_cmp_gt_i32 s[92:93], 24, v43
    v_cmp_gt_i32 s[94:95], 25, v43
    v_cmp_gt_i32 s[96:97], 26, v43
    v_cmp_gt_i32 s[98:99], 27, v43
    v_mov_b32 v104, 0xffff0000
    v_cndmask_b32 v96, 0, v104, s[66:67]
    v_cndmask_b32 v97, 0, v104, s[70:71]
    v_cndmask_b32 v98, 0, v104, s[78:79]
    v_cndmask_b32 v99, 0, v104, s[82:83]
    v_cndmask_b32 v100, 0, v104, s[86:87]
    v_cndmask_b32 v101, 0, v104, s[90:91]
    v_cndmask_b32 v102, 0, v104, s[94:95]
    v_cndmask_b32 v103, 0, v104, s[98:99]
    v_cndmask_b32 v96, v96, -1, s[64:65]
    v_cndmask_b32 v97, v97, -1, s[68:69]
    v_cndmask_b32 v98, v98, -1, s[76:77]
    v_cndmask_b32 v99, v99, -1, s[80:81]
    v_cndmask_b32 v100, v100, -1, s[84:85]
    v_cndmask_b32 v101, v101, -1, s[88:89]
    v_cndmask_b32 v102, v102, -1, s[92:93]
    v_cndmask_b32 v103, v103, -1, s[96:97]
    s_waitcnt vmcnt(0)
Lkvw_38:
    v_cndmask_b32 v228, 0, v228, s[60:61]
    v_cndmask_b32 v229, 0, v229, s[60:61]
    v_cndmask_b32 v230, 0, v230, s[62:63]
    v_cndmask_b32 v231, 0, v231, s[62:63]
    s_barrier
    s_lshl_b32 s52, s28, 2
    s_add_u32 s52, s52, s55
    s_sub_i32 s52, 8, s52
    s_mov_b32 s57, 0xf149f2ca
    ds_read_b128 v[232:235], v40 offset:0
    ds_read_b128 v[236:239], v41 offset:0
    ds_read_b128 v[240:243], v40 offset:4096
    ds_read_b128 v[244:247], v41 offset:4096
    s_waitcnt lgkmcnt(2)
    s_cmp_gt_i32 s52, 0
    s_cbranch_scc1 Lfinv_41
    v_mfma_f32_32x32x16_bf16 v[64:79], v[232:235], v[224:227], 0
    v_mfma_f32_32x32x16_bf16 v[64:79], v[236:239], v[228:231], v[64:79]
Lfinvb_42:
    s_waitcnt lgkmcnt(0)
    v_mfma_f32_32x32x16_bf16 v[80:95], v[240:243], v[224:227], 0
    v_mfma_f32_32x32x16_bf16 v[80:95], v[244:247], v[228:231], v[80:95]
    ds_read_b128 v[240:243], v40 offset:512
    ds_read_b128 v[244:247], v41 offset:512
    ds_read_b128 v[232:235], v40 offset:1024
    ds_read_b128 v[236:239], v41 offset:1024
    s_nop 7
    v_cndmask_b32 v64, v80, v64, s[64:65]
    v_cndmask_b32 v65, v81, v65, s[66:67]
    v_cndmask_b32 v66, v82, v66, s[68:69]
    v_cndmask_b32 v67, v83, v67, s[70:71]
    v_cndmask_b32 v68, v84, v68, s[76:77]
    v_cndmask_b32 v69, v85, v69, s[78:79]
    v_cndmask_b32 v70, v86, v70, s[80:81]
    v_cndmask_b32 v71, v87, v71, s[82:83]
    v_cndmask_b32 v72, v88, v72, s[84:85]
    v_cndmask_b32 v73, v89, v73, s[86:87]
    v_cndmask_b32 v74, v90, v74, s[88:89]
    v_cndmask_b32 v75, v91, v75, s[90:91]
    v_cndmask_b32 v76, v92, v76, s[92:93]
    v_cndmask_b32 v77, v93, v77, s[94:95]
    v_cndmask_b32 v78, v94, v78, s[96:97]
    v_cndmask_b32 v79, v95, v79, s[98:99]
    s_waitcnt lgkmcnt(2)
    s_cmp_gt_i32 s52, 1
    s_cbranch_scc1 Lfinv_43
    v_mfma_f32_32x32x16_bf16 v[80:95], v[240:243], v[224:227], 0
    v_mfma_f32_32x32x16_bf16 v[80:95], v[244:247], v[228:231], v[80:95]
Lfinvb_44:
    v_exp_f32 v64, v64
    v_exp_f32 v65, v65
    v_exp_f32 v66, v66
    v_exp_f32 v67, v67
    v_exp_f32 v68, v68
    v_exp_f32 v69, v69
    v_exp_f32 v70, v70
    v_exp_f32 v71, v71
    v_cvt_pk_bf16_f32 v16, v64, v65
    v_cvt_pk_bf16_f32 v17, v66, v67
    v_cvt_pk_bf16_f32 v18, v68, v69
    v_cvt_pk_bf16_f32 v19, v70, v71
    s_waitcnt vmcnt(0)
    s_barrier
    ds_read_b64_tr_b16 v[32:33], v42 offset:4096
    ds_read_b64_tr_b16 v[34:35], v42 offset:4224
    ds_read_b64_tr_b16 v[36:37], v42 offset:4352
    ds_read_b64_tr_b16 v[38:39], v42 offset:4480
    ds_read_b64_tr_b16 v[24:25], v42 offset:0
    ds_read_b64_tr_b16 v[26:27], v42 offset:128
    ds_read_b64_tr_b16 v[28:29], v42 offset:256
    ds_read_b64_tr_b16 v[30:31], v42 offset:384
    v_exp_f32 v72, v72
    v_exp_f32 v73, v73
    v_exp_f32 v74, v74
    v_exp_f32 v75, v75
    v_exp_f32 v76, v76
    v_exp_f32 v77, v77
    v_exp_f32 v78, v78
    v_exp_f32 v79, v79
    v_cvt_pk_bf16_f32 v20, v72, v73
    v_cvt_pk_bf16_f32 v21, v74, v75
    v_cvt_pk_bf16_f32 v22, v76, v77
    v_cvt_pk_bf16_f32 v23, v78, v79
    v_and_b32 v8, v96, v16
    v_and_b32 v9, v97, v17
    v_and_b32 v10, v98, v18
    v_and_b32 v11, v99, v19
    v_and_b32 v12, v100, v20
    v_and_b32 v13, v101, v21
    v_and_b32 v14, v102, v22
    v_and_b32 v15, v103, v23
    v_xor_b32 v16, v8, v16
    v_xor_b32 v17, v9, v17
    v_xor_b32 v18, v10, v18
    v_xor_b32 v19, v11, v19
    v_xor_b32 v20, v12, v20
    v_xor_b32 v21, v13, v21
    v_xor_b32 v22, v14, v22
    v_xor_b32 v23, v15, v23
    s_waitcnt lgkmcnt(4)
    v_mfma_f32_32x32x16_bf16 v[208:223], v[32:35], v[16:19], 0
    v_mfma_f32_32x32x16_bf16 v[208:223], v[36:39], v[20:23], v[208:223]
    s_waitcnt lgkmcnt(0)
    v_mfma_f32_32x32x16_bf16 v[208:223], v[24:27], v[8:11], v[208:223]
    v_mfma_f32_32x32x16_bf16 v[208:223], v[28:31], v[12:15], v[208:223]
    ds_read_b64_tr_b16 v[32:33], v42 offset:512
    ds_read_b64_tr_b16 v[34:35], v42 offset:640
    ds_read_b64_tr_b16 v[36:37], v42 offset:768
    ds_read_b64_tr_b16 v[38:39], v42 offset:896
    s_mov_b32 s53, 16384
    buffer_load_dword v252, off, s[16:19], s53 sc1
    s_cmp_ge_u32 s30, 3
    s_cbranch_scc1 Lpfc_45
    s_cmp_eq_u32 s30, 1
    s_cselect_b32 s60, s42, s40
    s_cselect_b32 s61, s43, s41
    s_cmp_eq_u32 s30, 2
    s_cselect_b32 s60, s44, s60
    s_cselect_b32 s61, s45, s61
    s_mul_i32 s58, s2, 68
    v_add_u32 v50, s58, v0
    v_min_u32 v50, 17279, v50
    v_lshlrev_b32 v50, 7, v50
    global_load_dword v249, v50, s[60:61]
    v_and_b32 v50, 3, v0
    s_add_u32 s58, s58, 64
    v_add_u32 v50, s58, v50
    v_min_u32 v50, 17279, v50
    v_lshlrev_b32 v50, 7, v50
    global_load_dword v250, v50, s[60:61]
Lpfc_45:
    ds_read_b128 v[240:243], v40 offset:1536
    ds_read_b128 v[244:247], v41 offset:1536
    s_waitcnt lgkmcnt(6)
    s_cmp_gt_i32 s52, 2
    s_cbranch_scc1 Lfinv_46
    v_mfma_f32_32x32x16_bf16 v[64:79], v[232:235], v[224:227], 0
    v_mfma_f32_32x32x16_bf16 v[64:79], v[236:239], v[228:231], v[64:79]
Lfinvb_47:
    ds_read_b64_tr_b16 v[24:25], v42 offset:1024
    ds_read_b64_tr_b16 v[26:27], v42 offset:1152
    ds_read_b64_tr_b16 v[28:29], v42 offset:1280
    ds_read_b64_tr_b16 v[30:31], v42 offset:1408
    v_exp_f32 v80, v80
    v_exp_f32 v81, v81
    v_exp_f32 v82, v82
    v_exp_f32 v83, v83
    v_exp_f32 v84, v84
    v_exp_f32 v85, v85
    v_exp_f32 v86, v86
    v_exp_f32 v87, v87
    v_cvt_pk_bf16_f32 v16, v80, v81
    v_cvt_pk_bf16_f32 v17, v82, v83
    v_cvt_pk_bf16_f32 v18, v84, v85
    v_cvt_pk_bf16_f32 v19, v86, v87
    s_waitcnt lgkmcnt(8)
    s_nop 0
    v_mfma_f32_32x32x16_bf16 v[208:223], v[32:35], v[16:19], v[208:223]
    v_exp_f32 v88, v88
    v_exp_f32 v89, v89
    v_exp_f32 v90, v90
    v_exp_f32 v91, v91
    v_exp_f32 v92, v92
    v_exp_f32 v93, v93
    v_exp_f32 v94, v94
    v_exp_f32 v95, v95
    v_cvt_pk_bf16_f32 v20, v88, v89
    v_cvt_pk_bf16_f32 v21, v90, v91
    v_cvt_pk_bf16_f32 v22, v92, v93
    v_cvt_pk_bf16_f32 v23, v94, v95
    s_waitcnt lgkmcnt(6)
    s_nop 0
    v_mfma_f32_32x32x16_bf16 v[208:223], v[36:39], v[20:23], v[208:223]
    ds_read_b128 v[232:235], v40 offset:2048
    ds_read_b128 v[236:239], v41 offset:2048
    s_waitcnt lgkmcnt(6)
    s_cmp_gt_i32 s52, 3
    s_cbranch_scc1 Lfinv_48
    v_mfma_f32_32x32x16_bf16 v[80:95], v[240:243], v[224:227], 0
    v_mfma_f32_32x32x16_bf16 v[80:95], v[244:247], v[228:231], v[80:95]
Lfinvb_49:
    ds_read_b64_tr_b16 v[32:33], v42 offset:1536
    ds_read_b64_tr_b16 v[34:35], v42 offset:1664
    ds_read_b64_tr_b16 v[36:37], v42 offset:1792
    ds_read_b64_tr_b16 v[38:39], v42 offset:1920
    v_exp_f32 v64, v64
    v_exp_f32 v65, v65
    v_exp_f32 v66, v66
    v_exp_f32 v67, v67
    v_exp_f32 v68, v68
    v_exp_f32 v69, v69
    v_exp_f32 v70, v70
    v_exp_f32 v71, v71
    v_cvt_pk_bf16_f32 v8, v64, v65
    v_cvt_pk_bf16_f32 v9, v66, v67
    v_cvt_pk_bf16_f32 v10, v68, v69
    v_cvt_pk_bf16_f32 v11, v70, v71
    s_waitcnt lgkmcnt(8)
    s_nop 0
    v_mfma_f32_32x32x16_bf16 v[208:223], v[24:27], v[8:11], v[208:223]
    v_exp_f32 v72, v72
    v_exp_f32 v73, v73
    v_exp_f32 v74, v74
    v_exp_f32 v75, v75
    v_exp_f32 v76, v76
    v_exp_f32 v77, v77
    v_exp_f32 v78, v78
    v_exp_f32 v79, v79
    v_cvt_pk_bf16_f32 v12, v72, v73
    v_cvt_pk_bf16_f32 v13, v74, v75
    v_cvt_pk_bf16_f32 v14, v76, v77
    v_cvt_pk_bf16_f32 v15, v78, v79
    s_waitcnt lgkmcnt(6)
    s_nop 0
    v_mfma_f32_32x32x16_bf16 v[208:223], v[28:31], v[12:15], v[208:223]
    ds_read_b128 v[240:243], v40 offset:2560
    ds_read_b128 v[244:247], v41 offset:2560
    s_waitcnt lgkmcnt(6)
    s_cmp_gt_i32 s52, 4
    s_cbranch_scc1 Lfinv_50
    v_mfma_f32_32x32x16_bf16 v[64:79], v[232:235], v[224:227], 0
    v_mfma_f32_32x32x16_bf16 v[64:79], v[236:239], v[228:231], v[64:79]
Lfinvb_51:
    ds_read_b64_tr_b16 v[24:25], v42 offset:2048
    ds_read_b64_tr_b16 v[26:27], v42 offset:2176
    ds_read_b64_tr_b16 v[28:29], v42 offset:2304
    ds_read_b64_tr_b16 v[30:31], v42 offset:2432
    v_exp_f32 v80, v80
    v_exp_f32 v81, v81
    v_exp_f32 v82, v82
    v_exp_f32 v83, v83
    v_exp_f32 v84, v84
    v_exp_f32 v85, v85
    v_exp_f32 v86, v86
    v_exp_f32 v87, v87
    v_cvt_pk_bf16_f32 v16, v80, v81
    v_cvt_pk_bf16_f32 v17, v82, v83
    v_cvt_pk_bf16_f32 v18, v84, v85
    v_cvt_pk_bf16_f32 v19, v86, v87
    s_waitcnt lgkmcnt(8)
    s_nop 0
    v_mfma_f32_32x32x16_bf16 v[208:223], v[32:35], v[16:19], v[208:223]
    v_exp_f32 v88, v88
    v_exp_f32 v89, v89
    v_exp_f32 v90, v90
    v_exp_f32 v91, v91
    v_exp_f32 v92, v92
    v_exp_f32 v93, v93
    v_exp_f32 v94, v94
    v_exp_f32 v95, v95
    v_cvt_pk_bf16_f32 v20, v88, v89
    v_cvt_pk_bf16_f32 v21, v90, v91
    v_cvt_pk_bf16_f32 v22, v92, v93
    v_cvt_pk_bf16_f32 v23, v94, v95
    s_waitcnt lgkmcnt(6)
    s_nop 0
    v_mfma_f32_32x32x16_bf16 v[208:223], v[36:39], v[20:23], v[208:223]
    ds_read_b128 v[232:235], v40 offset:3072
    ds_read_b128 v[236:239], v41 offset:3072
    s_waitcnt lgkmcnt(6)
    s_cmp_gt_i32 s52, 5
    s_cbranch_scc1 Lfinv_52
    v_mfma_f32_32x32x16_bf16 v[80:95], v[240:243], v[224:227], 0
    v_mfma_f32_32x32x16_bf16 v[80:95], v[244:247], v[228:231], v[80:95]
Lfinvb_53:
    ds_read_b64_tr_b16 v[32:33], v42 offset:2560
    ds_read_b64_tr_b16 v[34:35], v42 offset:2688
    ds_read_b64_tr_b16 v[36:37], v42 offset:2816
    ds_read_b64_tr_b16 v[38:39], v42 offset:2944
    v_exp_f32 v64, v64
    v_exp_f32 v65, v65
    v_exp_f32 v66, v66
    v_exp_f32 v67, v67
    v_exp_f32 v68, v68
    v_exp_f32 v69, v69
    v_exp_f32 v70, v70
    v_exp_f32 v71, v71
    v_cvt_pk_bf16_f32 v8, v64, v65
    v_cvt_pk_bf16_f32 v9, v66, v67
    v_cvt_pk_bf16_f32 v10, v68, v69
    v_cvt_pk_bf16_f32 v11, v70, v71
    s_waitcnt lgkmcnt(8)
    s_nop 0
    v_mfma_f32_32x32x16_bf16 v[208:223], v[24:27], v[8:11], v[208:223]
    v_exp_f32 v72, v72
    v_exp_f32 v73, v73
    v_exp_f32 v74, v74
    v_exp_f32 v75, v75
    v_exp_f32 v76, v76
    v_exp_f32 v77, v77
    v_exp_f32 v78, v78
    v_exp_f32 v79, v79
    v_cvt_pk_bf16_f32 v12, v72, v73
    v_cvt_pk_bf16_f32 v13, v74, v75
    v_cvt_pk_bf16_f32 v14, v76, v77
    v_cvt_pk_bf16_f32 v15, v78, v79
    s_waitcnt lgkmcnt(6)
    s_nop 0
    v_mfma_f32_32x32x16_bf16 v[208:223], v[28:31], v[12:15], v[208:223]
    ds_read_b128 v[240:243], v40 offset:3584
    ds_read_b128 v[244:247], v41 offset:3584
    s_waitcnt lgkmcnt(6)
    s_cmp_gt_i32 s52, 6
    s_cbranch_scc1 Lfinv_54
    v_mfma_f32_32x32x16_bf16 v[64:79], v[232:235], v[224:227], 0
    v_mfma_f32_32x32x16_bf16 v[64:79], v[236:239], v[228:231], v[64:79]
Lfinvb_55:
    ds_read_b64_tr_b16 v[24:25], v42 offset:3072
    ds_read_b64_tr_b16 v[26:27], v42 offset:3200
    ds_read_b64_tr_b16 v[28:29], v42 offset:3328
    ds_read_b64_tr_b16 v[30:31], v42 offset:3456
    v_exp_f32 v80, v80
    v_exp_f32 v81, v81
    v_exp_f32 v82, v82
    v_exp_f32 v83, v83
    v_exp_f32 v84, v84
    v_exp_f32 v85, v85
    v_exp_f32 v86, v86
    v_exp_f32 v87, v87
    v_cvt_pk_bf16_f32 v16, v80, v81
    v_cvt_pk_bf16_f32 v17, v82, v83
    v_cvt_pk_bf16_f32 v18, v84, v85
    v_cvt_pk_bf16_f32 v19, v86, v87
    s_waitcnt lgkmcnt(8)
    s_nop 0
    v_mfma_f32_32x32x16_bf16 v[208:223], v[32:35], v[16:19], v[208:223]
    v_exp_f32 v88, v88
    v_exp_f32 v89, v89
    v_exp_f32 v90, v90
    v_exp_f32 v91, v91
    v_exp_f32 v92, v92
    v_exp_f32 v93, v93
    v_exp_f32 v94, v94
    v_exp_f32 v95, v95
    v_cvt_pk_bf16_f32 v20, v88, v89
    v_cvt_pk_bf16_f32 v21, v90, v91
    v_cvt_pk_bf16_f32 v22, v92, v93
    v_cvt_pk_bf16_f32 v23, v94, v95
    s_waitcnt lgkmcnt(6)
    s_nop 0
    v_mfma_f32_32x32x16_bf16 v[208:223], v[36:39], v[20:23], v[208:223]
    s_waitcnt lgkmcnt(4)
    s_cmp_gt_i32 s52, 7
    s_cbranch_scc1 Lfinv_56
    v_mfma_f32_32x32x16_bf16 v[80:95], v[240:243], v[224:227], 0
    v_mfma_f32_32x32x16_bf16 v[80:95], v[244:247], v[228:231], v[80:95]
Lfinvb_57:
    ds_read_b64_tr_b16 v[32:33], v42 offset:3584
    ds_read_b64_tr_b16 v[34:35], v42 offset:3712
    ds_read_b64_tr_b16 v[36:37], v42 offset:3840
    ds_read_b64_tr_b16 v[38:39], v42 offset:3968
    v_exp_f32 v64, v64
    v_exp_f32 v65, v65
    v_exp_f32 v66, v66
    v_exp_f32 v67, v67
    v_exp_f32 v68, v68
    v_exp_f32 v69, v69
    v_exp_f32 v70, v70
    v_exp_f32 v71, v71
    v_cvt_pk_bf16_f32 v8, v64, v65
    v_cvt_pk_bf16_f32 v9, v66, v67
    v_cvt_pk_bf16_f32 v10, v68, v69
    v_cvt_pk_bf16_f32 v11, v70, v71
    s_waitcnt lgkmcnt(6)
    s_nop 0
    v_mfma_f32_32x32x16_bf16 v[208:223], v[24:27], v[8:11], v[208:223]
    v_exp_f32 v72, v72
    v_exp_f32 v73, v73
    v_exp_f32 v74, v74
    v_exp_f32 v75, v75
    v_exp_f32 v76, v76
    v_exp_f32 v77, v77
    v_exp_f32 v78, v78
    v_exp_f32 v79, v79
    v_cvt_pk_bf16_f32 v12, v72, v73
    v_cvt_pk_bf16_f32 v13, v74, v75
    v_cvt_pk_bf16_f32 v14, v76, v77
    v_cvt_pk_bf16_f32 v15, v78, v79
    s_waitcnt lgkmcnt(4)
    s_nop 0
    v_mfma_f32_32x32x16_bf16 v[208:223], v[28:31], v[12:15], v[208:223]
    v_exp_f32 v80, v80
    v_exp_f32 v81, v81
    v_exp_f32 v82, v82
    v_exp_f32 v83, v83
    v_exp_f32 v84, v84
    v_exp_f32 v85, v85
    v_exp_f32 v86, v86
    v_exp_f32 v87, v87
    v_cvt_pk_bf16_f32 v16, v80, v81
    v_cvt_pk_bf16_f32 v17, v82, v83
    v_cvt_pk_bf16_f32 v18, v84, v85
    v_cvt_pk_bf16_f32 v19, v86, v87
    s_waitcnt lgkmcnt(2)
    s_nop 0
    v_mfma_f32_32x32x16_bf16 v[208:223], v[32:35], v[16:19], v[208:223]
    v_exp_f32 v88, v88
    v_exp_f32 v89, v89
    v_exp_f32 v90, v90
    v_exp_f32 v91, v91
    v_exp_f32 v92, v92
    v_exp_f32 v93, v93
    v_exp_f32 v94, v94
    v_exp_f32 v95, v95
    v_cvt_pk_bf16_f32 v20, v88, v89
    v_cvt_pk_bf16_f32 v21, v90, v91
    v_cvt_pk_bf16_f32 v22, v92, v93
    v_cvt_pk_bf16_f32 v23, v94, v95
    s_waitcnt lgkmcnt(0)
    s_nop 0
    v_mfma_f32_32x32x16_bf16 v[208:223], v[36:39], v[20:23], v[208:223]
    s_mov_b32 s60, 0x21800000
    s_mov_b32 s61, 0x5d800000
    v_mov_b32 v44, 0
    s_nop 8
    v_fma_f32 v44, v208, 0, v44
    v_fma_f32 v44, v209, 0, v44
    v_fma_f32 v44, v210, 0, v44
    v_fma_f32 v44, v211, 0, v44
    v_fma_f32 v44, v212, 0, v44
    v_fma_f32 v44, v213, 0, v44
    v_fma_f32 v44, v214, 0, v44
    v_fma_f32 v44, v215, 0, v44
    v_fma_f32 v44, v216, 0, v44
    v_fma_f32 v44, v217, 0, v44
    v_fma_f32 v44, v218, 0, v44
    v_fma_f32 v44, v219, 0, v44
    v_cmp_le_f32 s[62:63], s60, v220
    v_cmp_ge_f32 s[64:65], s61, v220
    v_cmp_o_f32 vcc, v44, v44
    s_and_b64 s[62:63], s[62:63], s[64:65]
    s_and_b64 vcc, vcc, s[62:63]
    s_cmp_eq_u64 vcc, -1
    s_cbranch_scc0 Lslow_39
Lnorm_40:
    s_nop 10
    v_rcp_f32 v46, v220
    s_nop 0
    v_pk_mul_f32 v[208:209], v[208:209], v[46:47] op_sel_hi:[1,0]
    v_pk_mul_f32 v[210:211], v[210:211], v[46:47] op_sel_hi:[1,0]
    v_pk_mul_f32 v[212:213], v[212:213], v[46:47] op_sel_hi:[1,0]
    v_pk_mul_f32 v[214:215], v[214:215], v[46:47] op_sel_hi:[1,0]
    v_pk_mul_f32 v[216:217], v[216:217], v[46:47] op_sel_hi:[1,0]
    v_pk_mul_f32 v[218:219], v[218:219], v[46:47] op_sel_hi:[1,0]
    v_cvt_pk_bf16_f32 v48, v208, v209
    v_cvt_pk_bf16_f32 v49, v210, v211
    v_cvt_pk_bf16_f32 v50, v212, v213
    v_cvt_pk_bf16_f32 v51, v214, v215
    v_cvt_pk_bf16_f32 v52, v216, v217
    v_cvt_pk_bf16_f32 v53, v218, v219
    v_permlane32_swap_b32 v48, v50
    v_permlane32_swap_b32 v49, v51
    s_mul_i32 s53, s29, 5
    s_add_u32 s57, s53, s56
    s_lshl_b32 s57, s57, 15
    s_add_u32 s57, s57, s59
    s_add_u32 s57, s57, 13631488
    buffer_store_dwordx4 v[48:51], v5, s[16:19], s57 offen sc1
    s_add_u32 s57, s53, 2
    s_lshl_b32 s57, s57, 15
    s_add_u32 s57, s57, s59
    s_lshl_b32 s53, s54, 3
    s_add_u32 s57, s57, s53
    s_add_u32 s57, s57, 13631488
    s_mov_b32 exec_hi, 0
    buffer_store_dwordx2 v[52:53], v4, s[16:19], s57 offen sc1
    s_mov_b32 exec_hi, -1
    s_waitcnt vmcnt(0)
    s_barrier
    s_cmp_lg_u32 s30, 4
    s_cbranch_scc1 Lnosig_74
    s_lshl_b32 s52, s28, 6
    s_add_u32 s52, s52, s29
    s_add_u32 s52, s52, 16
    s_mul_i32 s52, s52, 128
    s_add_u32 s52, s52, 131072
    v_mov_b32 v1, 1
    s_mov_b64 exec, 1
    buffer_store_dword v1, off, s[16:19], s52 sc1
    s_mov_b64 exec, -1
Lnosig_74:
    v_readfirstlane_b32 s52, v252
    s_nop 3
    s_cmp_ge_u32 s52, 16
    s_cbranch_scc0 Laxp_75
Laxb_76:
    s_cmp_ge_u32 s30, 4
    s_cbranch_scc1 Lp3ld_79
    s_and_b32 s54, s30, 1
    s_lshr_b32 s55, s30, 1
    v_lshrrev_b32 v1, 4, v0
    v_and_b32 v2, 15, v0
    s_lshl_b32 s52, s54, 5
    v_add_u32 v3, s52, v2
    v_lshlrev_b32 v4, 4, v3
    v_lshl_add_u32 v42, v1, 10, v4
    v_lshrrev_b32 v5, 1, v1
    v_lshlrev_b32 v5, 4, v5
    v_and_b32 v6, 1, v1
    v_lshl_add_u32 v5, v6, 2, v5
    v_bfe_u32 v6, v0, 2, 2
    v_add_u32 v5, v5, v6
    v_mul_u32_u24 v5, 160, v5
    v_and_b32 v6, 3, v0
    v_lshl_add_u32 v5, v6, 3, v5
    s_lshl_b32 s52, s55, 6
    s_add_u32 s52, s52, 8192
    v_add_u32 v43, s52, v5
    s_lshl_b32 s52, s28, 7
    s_and_b32 s53, s29, 1
    s_lshl_b32 s53, s53, 6
    s_add_u32 s58, s52, s53
    v_add_u32 v44, s58, v3
    s_lshr_b32 s52, s29, 1
    s_mul_i32 s59, s52, 80
    s_lshl_b32 s53, s55, 5
    s_add_u32 s59, s59, s53
    v_and_b32 v2, 15, v0
    v_bfe_u32 v3, v0, 4, 1
    v_lshl_add_u32 v2, v3, 4, v2
    s_lshl_b32 s53, s54, 5
    s_add_u32 s53, s53, s58
    v_add_u32 v2, s53, v2
    v_lshrrev_b32 v3, 5, v0
    v_lshlrev_b32 v2, 4, v2
    v_lshl_add_u32 v46, v3, 15, v2
    s_lshl_b32 s60, s59, 12
    s_add_u32 s60, s60, 16777216
    s_lshr_b32 s52, s29, 1
    s_lshl_b32 s52, s52, 1
    s_add_u32 s52, s52, s55
    s_lshl_b32 s52, s52, 14
    s_lshl_b32 s53, s53, 3
    s_add_u32 s52, s52, s53
    s_add_u32 s61, s52, 524288
    v_and_b32 v2, 31, v0
    v_lshlrev_b32 v47, 3, v2
    s_cmp_lg_u32 s30, 0
    s_cbranch_scc1 Lnopoll_81
    v_and_b32 v3, 15, v0
    s_lshl_b32 s52, s28, 6
    s_add_u32 s52, s52, 16
    v_add_u32 v2, s52, v3
    v_mul_u32_u24 v2, 128, v2
    v_add_u32 v2, 131072, v2
    v_cmp_gt_u32 vcc, 16, v3
    s_nop 1
    v_cndmask_b32 v3, 0, 1, vcc
    s_mov_b32 s52, 40000
Lpoll_82:
    buffer_load_dword v1, v2, s[16:19], 0 offen sc1
    s_waitcnt vmcnt(0)
    v_cmp_le_u32 vcc, v3, v1
    s_cmp_eq_u64 vcc, -1
    s_cbranch_scc1 Lpolld_83
    s_sleep 1
    s_sub_u32 s52, s52, 1
    s_cmp_lg_u32 s52, 0
    s_cbranch_scc1 Lpoll_82
Lpolld_83:
Lnopoll_81:
    s_barrier
    v_mul_u32_u24 v45, 1280, v44
    v_lshrrev_b32 v1, 4, v0
    v_lshl_add_u32 v45, v1, 3, v45
    s_lshl_b32 s52, s59, 1
    s_add_u32 s53, s52, 0
    buffer_load_dwordx2 v[88:89], v45, s[4:7], s53 offen offset:0
    s_add_u32 s53, s52, 20480
    buffer_load_dwordx2 v[90:91], v45, s[4:7], s53 offen offset:0
    s_add_u32 s53, s52, 0
    buffer_load_dwordx2 v[92:93], v45, s[4:7], s53 offen offset:32
    s_add_u32 s53, s52, 20480
    buffer_load_dwordx2 v[94:95], v45, s[4:7], s53 offen offset:32
    s_add_u32 s53, s52, 0
    buffer_load_dwordx2 v[96:97], v45, s[4:7], s53 offen offset:64
    s_add_u32 s53, s52, 20480
    buffer_load_dwordx2 v[98:99], v45, s[4:7], s53 offen offset:64
    v_lshrrev_b32 v1, 4, v0
    s_mov_b32 s56, 0
    s_mov_b32 s57, 0
    v_mov_b32 v40, v42
    v_mov_b32 v41, v43
    s_barrier
    ds_read_b64_tr_b16 v[112:113], v41 offset:0
    ds_read_b64_tr_b16 v[114:115], v41 offset:1280
    ds_read_b128 v[104:107], v40 offset:0
    ds_read_b64_tr_b16 v[116:117], v41 offset:32
    ds_read_b64_tr_b16 v[118:119], v41 offset:1312
    ds_read_b128 v[108:111], v40 offset:256
    ds_read_b64_tr_b16 v[120:121], v41 offset:64
    ds_read_b64_tr_b16 v[122:123], v41 offset:1344
    ds_read_b64_tr_b16 v[132:133], v41 offset:5120
    ds_read_b64_tr_b16 v[134:135], v41 offset:6400
    ds_read_b128 v[124:127], v40 offset:4096
    ds_read_b64_tr_b16 v[136:137], v41 offset:5152
    ds_read_b64_tr_b16 v[138:139], v41 offset:6432
    ds_read_b128 v[128:131], v40 offset:4352
    ds_read_b64_tr_b16 v[140:141], v41 offset:5184
    ds_read_b64_tr_b16 v[142:143], v41 offset:6464
    s_waitcnt vmcnt(0)
    v_lshlrev_b32 v64, 16, v88
    v_and_b32 v65, 0xffff0000, v88
    v_lshlrev_b32 v66, 16, v89
    v_and_b32 v67, 0xffff0000, v89
    v_lshlrev_b32 v68, 16, v90
    v_and_b32 v69, 0xffff0000, v90
    v_lshlrev_b32 v70, 16, v91
    v_and_b32 v71, 0xffff0000, v91
    v_lshlrev_b32 v72, 16, v92
    v_and_b32 v73, 0xffff0000, v92
    v_lshlrev_b32 v74, 16, v93
    v_and_b32 v75, 0xffff0000, v93
    v_lshlrev_b32 v76, 16, v94
    v_and_b32 v77, 0xffff0000, v94
    v_lshlrev_b32 v78, 16, v95
    v_and_b32 v79, 0xffff0000, v95
    v_lshlrev_b32 v80, 16, v96
    v_and_b32 v81, 0xffff0000, v96
    v_lshlrev_b32 v82, 16, v97
    v_and_b32 v83, 0xffff0000, v97
    v_lshlrev_b32 v84, 16, v98
    v_and_b32 v85, 0xffff0000, v98
    v_lshlrev_b32 v86, 16, v99
    v_and_b32 v87, 0xffff0000, v99
Lg80c_84:
    s_add_u32 s56, s56, 18432
    s_cmp_eq_u32 s56, 147456
    s_cselect_b32 s56, 0, s56
    s_add_u32 s57, s57, 1
    v_add_u32 v40, s56, v42
    v_add_u32 v41, s56, v43
    s_cmp_eq_u32 s57, 10
    s_waitcnt lgkmcnt(0)
    s_barrier
    v_mfma_f32_16x16x32_bf16 v[64:67], v[112:115], v[104:107], v[64:67]
    ds_read_b64_tr_b16 v[152:153], v41 offset:0
    ds_read_b64_tr_b16 v[154:155], v41 offset:1280
    v_mfma_f32_16x16x32_bf16 v[68:71], v[112:115], v[108:111], v[68:71]
    ds_read_b128 v[144:147], v40 offset:0
    ds_read_b64_tr_b16 v[156:157], v41 offset:32
    v_mfma_f32_16x16x32_bf16 v[72:75], v[116:119], v[104:107], v[72:75]
    ds_read_b64_tr_b16 v[158:159], v41 offset:1312
    ds_read_b128 v[148:151], v40 offset:256
    v_mfma_f32_16x16x32_bf16 v[76:79], v[116:119], v[108:111], v[76:79]
    ds_read_b64_tr_b16 v[160:161], v41 offset:64
    ds_read_b64_tr_b16 v[162:163], v41 offset:1344
    v_mfma_f32_16x16x32_bf16 v[80:83], v[120:123], v[104:107], v[80:83]
    ds_read_b64_tr_b16 v[172:173], v41 offset:5120
    ds_read_b64_tr_b16 v[174:175], v41 offset:6400
    v_mfma_f32_16x16x32_bf16 v[84:87], v[120:123], v[108:111], v[84:87]
    ds_read_b128 v[164:167], v40 offset:4096
    ds_read_b64_tr_b16 v[176:177], v41 offset:5152
    v_mfma_f32_16x16x32_bf16 v[64:67], v[132:135], v[124:127], v[64:67]
    ds_read_b64_tr_b16 v[178:179], v41 offset:6432
    ds_read_b128 v[168:171], v40 offset:4352
    v_mfma_f32_16x16x32_bf16 v[68:71], v[132:135], v[128:131], v[68:71]
    ds_read_b64_tr_b16 v[180:181], v41 offset:5184
    ds_read_b64_tr_b16 v[182:183], v41 offset:6464
    v_mfma_f32_16x16x32_bf16 v[72:75], v[136:139], v[124:127], v[72:75]
    v_mfma_f32_16x16x32_bf16 v[76:79], v[136:139], v[128:131], v[76:79]
    v_mfma_f32_16x16x32_bf16 v[80:83], v[140:143], v[124:127], v[80:83]
    v_mfma_f32_16x16x32_bf16 v[84:87], v[140:143], v[128:131], v[84:87]
    s_add_u32 s56, s56, 18432
    s_cmp_eq_u32 s56, 147456
    s_cselect_b32 s56, 0, s56
    s_add_u32 s57, s57, 1
    v_add_u32 v40, s56, v42
    v_add_u32 v41, s56, v43
    s_cmp_eq_u32 s57, 10
    s_cbranch_scc1 Lg80x_86
    s_waitcnt lgkmcnt(0)
    s_barrier
    v_mfma_f32_16x16x32_bf16 v[64:67], v[152:155], v[144:147], v[64:67]
    ds_read_b64_tr_b16 v[112:113], v41 offset:0
    ds_read_b64_tr_b16 v[114:115], v41 offset:1280
    v_mfma_f32_16x16x32_bf16 v[68:71], v[152:155], v[148:151], v[68:71]
    ds_read_b128 v[104:107], v40 offset:0
    ds_read_b64_tr_b16 v[116:117], v41 offset:32
    v_mfma_f32_16x16x32_bf16 v[72:75], v[156:159], v[144:147], v[72:75]
    ds_read_b64_tr_b16 v[118:119], v41 offset:1312
    ds_read_b128 v[108:111], v40 offset:256
    v_mfma_f32_16x16x32_bf16 v[76:79], v[156:159], v[148:151], v[76:79]
    ds_read_b64_tr_b16 v[120:121], v41 offset:64
    ds_read_b64_tr_b16 v[122:123], v41 offset:1344
    v_mfma_f32_16x16x32_bf16 v[80:83], v[160:163], v[144:147], v[80:83]
    ds_read_b64_tr_b16 v[132:133], v41 offset:5120
    ds_read_b64_tr_b16 v[134:135], v41 offset:6400
    v_mfma_f32_16x16x32_bf16 v[84:87], v[160:163], v[148:151], v[84:87]
    ds_read_b128 v[124:127], v40 offset:4096
    ds_read_b64_tr_b16 v[136:137], v41 offset:5152
    v_mfma_f32_16x16x32_bf16 v[64:67], v[172:175], v[164:167], v[64:67]
    ds_read_b64_tr_b16 v[138:139], v41 offset:6432
    ds_read_b128 v[128:131], v40 offset:4352
    v_mfma_f32_16x16x32_bf16 v[68:71], v[172:175], v[168:171], v[68:71]
    ds_read_b64_tr_b16 v[140:141], v41 offset:5184
    ds_read_b64_tr_b16 v[142:143], v41 offset:6464
    v_mfma_f32_16x16x32_bf16 v[72:75], v[176:179], v[164:167], v[72:75]
    v_mfma_f32_16x16x32_bf16 v[76:79], v[176:179], v[168:171], v[76:79]
    v_mfma_f32_16x16x32_bf16 v[80:83], v[180:183], v[164:167], v[80:83]
    v_mfma_f32_16x16x32_bf16 v[84:87], v[180:183], v[168:171], v[84:87]
    s_branch Lg80c_84
Lg80x_86:
    s_waitcnt lgkmcnt(0)
    v_mfma_f32_16x16x32_bf16 v[64:67], v[152:155], v[144:147], v[64:67]
    v_mfma_f32_16x16x32_bf16 v[68:71], v[152:155], v[148:151], v[68:71]
    v_mfma_f32_16x16x32_bf16 v[72:75], v[156:159], v[144:147], v[72:75]
    v_mfma_f32_16x16x32_bf16 v[76:79], v[156:159], v[148:151], v[76:79]
    v_mfma_f32_16x16x32_bf16 v[80:83], v[160:163], v[144:147], v[80:83]
    v_mfma_f32_16x16x32_bf16 v[84:87], v[160:163], v[148:151], v[84:87]
    v_mfma_f32_16x16x32_bf16 v[64:67], v[172:175], v[164:167], v[64:67]
    v_mfma_f32_16x16x32_bf16 v[68:71], v[172:175], v[168:171], v[68:71]
    v_mfma_f32_16x16x32_bf16 v[72:75], v[176:179], v[164:167], v[72:75]
    v_mfma_f32_16x16x32_bf16 v[76:79], v[176:179], v[168:171], v[76:79]
    v_mfma_f32_16x16x32_bf16 v[80:83], v[180:183], v[164:167], v[80:83]
    v_mfma_f32_16x16x32_bf16 v[84:87], v[180:183], v[168:171], v[84:87]
    s_waitcnt vmcnt(0) lgkmcnt(0)
    s_cmp_lg_u32 s55, 0
    s_cbranch_scc1 Lskipst_88
    v_cvt_pk_bf16_f32 v8, v64, v65
    v_cvt_pk_bf16_f32 v9, v66, v67
    v_cvt_pk_bf16_f32 v10, v68, v69
    v_cvt_pk_bf16_f32 v11, v70, v71
    s_nop 0
    v_permlane16_swap_b32 v8, v10
    v_permlane16_swap_b32 v9, v11
    s_add_u32 s53, s60, 0
    buffer_store_dwordx4 v[8:11], v46, s[16:19], s53 offen sc1
Lskipst_88:
    s_nop 1
    v_cvt_pk_bf16_f32 v12, v72, v73
    v_cvt_pk_bf16_f32 v13, v74, v75
    v_cvt_pk_bf16_f32 v14, v76, v77
    v_cvt_pk_bf16_f32 v15, v78, v79
    s_nop 0
    v_permlane16_swap_b32 v12, v14
    v_permlane16_swap_b32 v13, v15
    s_add_u32 s53, s60, 65536
    buffer_store_dwordx4 v[12:15], v46, s[16:19], s53 offen sc1
    v_cvt_pk_bf16_f32 v16, v80, v81
    v_cvt_pk_bf16_f32 v17, v82, v83
    v_cvt_pk_bf16_f32 v18, v84, v85
    v_cvt_pk_bf16_f32 v19, v86, v87
    s_nop 0
    v_permlane16_swap_b32 v16, v18
    v_permlane16_swap_b32 v17, v19
    s_add_u32 s53, s60, 131072
    buffer_store_dwordx4 v[16:19], v46, s[16:19], s53 offen sc1
    v_mov_b32 v48, 0
    v_mov_b32 v49, 0
    v_mov_b32 v52, 0
    v_mov_b32 v53, 0
    v_mov_b32 v50, 0
    v_mov_b32 v51, 0
    v_mov_b32 v54, 0
    v_mov_b32 v55, 0
    s_cmp_lg_u32 s55, 0
    s_cbranch_scc1 Lskip0_89
    v_pk_add_f32 v[48:49], v[48:49], v[64:65]
    v_pk_fma_f32 v[52:53], v[64:65], v[64:65], v[52:53]
    v_pk_add_f32 v[48:49], v[48:49], v[66:67]
    v_pk_fma_f32 v[52:53], v[66:67], v[66:67], v[52:53]
    v_pk_add_f32 v[50:51], v[50:51], v[68:69]
    v_pk_fma_f32 v[54:55], v[68:69], v[68:69], v[54:55]
    v_pk_add_f32 v[50:51], v[50:51], v[70:71]
    v_pk_fma_f32 v[54:55], v[70:71], v[70:71], v[54:55]
Lskip0_89:
    v_pk_add_f32 v[48:49], v[48:49], v[72:73]
    v_pk_fma_f32 v[52:53], v[72:73], v[72:73], v[52:53]
    v_pk_add_f32 v[48:49], v[48:49], v[74:75]
    v_pk_fma_f32 v[52:53], v[74:75], v[74:75], v[52:53]
    v_pk_add_f32 v[50:51], v[50:51], v[76:77]
    v_pk_fma_f32 v[54:55], v[76:77], v[76:77], v[54:55]
    v_pk_add_f32 v[50:51], v[50:51], v[78:79]
    v_pk_fma_f32 v[54:55], v[78:79], v[78:79], v[54:55]
    v_pk_add_f32 v[48:49], v[48:49], v[80:81]
    v_pk_fma_f32 v[52:53], v[80:81], v[80:81], v[52:53]
    v_pk_add_f32 v[48:49], v[48:49], v[82:83]
    v_pk_fma_f32 v[52:53], v[82:83], v[82:83], v[52:53]
    v_pk_add_f32 v[50:51], v[50:51], v[84:85]
    v_pk_fma_f32 v[54:55], v[84:85], v[84:85], v[54:55]
    v_pk_add_f32 v[50:51], v[50:51], v[86:87]
    v_pk_fma_f32 v[54:55], v[86:87], v[86:87], v[54:55]
    v_add_f32 v56, v48, v49
    v_add_f32 v57, v52, v53
    v_add_f32 v58, v50, v51
    v_add_f32 v59, v54, v55
    v_mov_b32 v60, v56
    v_mov_b32 v61, v57
    v_mov_b32 v62, v58
    v_mov_b32 v63, v59
    v_permlane16_swap_b32 v56, v60
    v_permlane16_swap_b32 v57, v61
    v_permlane16_swap_b32 v58, v62
    v_permlane16_swap_b32 v59, v63
    v_add_f32 v56, v56, v60
    v_add_f32 v57, v57, v61
    v_add_f32 v58, v58, v62
    v_add_f32 v59, v59, v63
    v_mov_b32 v60, v56
    v_mov_b32 v61, v57
    v_mov_b32 v62, v58
    v_mov_b32 v63, v59
    v_permlane32_swap_b32 v56, v60
    v_permlane32_swap_b32 v57, v61
    v_permlane32_swap_b32 v58, v62
    v_permlane32_swap_b32 v59, v63
    v_add_f32 v56, v56, v60
    v_add_f32 v57, v57, v61
    v_add_f32 v58, v58, v62
    v_add_f32 v59, v59, v63
    v_and_b32 v2, 16, v0
    v_cmp_eq_u32 vcc, 0, v2
    s_nop 1
    v_cndmask_b32 v56, v58, v56, vcc
    v_cndmask_b32 v57, v59, v57, vcc
    s_mov_b32 exec_hi, 0
    buffer_store_dwordx2 v[56:57], v47, s[16:19], s61 offen sc1
    s_mov_b32 exec_hi, -1
    s_waitcnt vmcnt(0)
    s_barrier
    s_branch Lp4_80
Lp3ld_79:
    s_sub_u32 s31, s30, 4
    v_lshlrev_b32 v10, 4, v0
    v_add_u32 v11, 31744, v10
    s_lshl_b32 s52, s31, 11
    v_add_u32 v12, s52, v10
    s_lshl_b32 s52, s31, 9
    s_add_u32 s52, s52, 8192
    v_add_u32 v13, s52, v10
    s_lshl_b32 s54, s31, 16
    s_lshl_b32 s52, s28, 11
    s_add_u32 s54, s54, s52
    s_and_b32 s52, s29, 1
    s_lshl_b32 s52, s52, 10
    s_add_u32 s54, s54, s52
    s_add_u32 s54, s54, 13631488
    s_lshr_b32 s52, s29, 1
    s_mul_i32 s55, s52, 102400
    s_add_u32 s55, s55, 1048576
    s_mov_b32 s56, 0
    s_lshl_b32 s58, s31, 11
    s_lshl_b32 s59, s31, 9
    s_add_u32 s59, s59, 16384
    s_add_u32 s60, s58, 8192
    s_mul_i32 s52, s31, 3072
    s_lshl_b32 s53, s31, 11
    s_add_u32 s53, s53, 2048
    s_cmp_lt_u32 s31, 2
    s_cselect_b32 s52, s52, s53
    v_add_u32 v12, s52, v10
    s_add_u32 s60, s52, 8192
    s_cmp_lt_u32 s31, 2
    s_cbranch_scc0 Lg80rb_90
    s_mov_b32 s57, 0
Lg80w_92:
    s_add_u32 m0, s56, s60
    s_nop 0
    buffer_load_dwordx4 v12, s[16:19], s55 offen offset:0 sc1 lds
    buffer_load_dwordx4 v12, s[16:19], s55 offen offset:1024 sc1 lds
    buffer_load_dwordx4 v12, s[16:19], s55 offen offset:2048 sc1 lds
    s_add_u32 s55, s55, 10240
    s_add_u32 s56, s56, 18432
    s_add_u32 s57, s57, 1
    s_cmp_lt_u32 s57, 7
    s_cbranch_scc1 Lg80w_92
    s_cmp_lg_u32 s30, 0
    s_cbranch_scc1 Lnopoll_93
    v_and_b32 v3, 15, v0
    s_lshl_b32 s52, s28, 6
    s_add_u32 s52, s52, 16
    v_add_u32 v2, s52, v3
    v_mul_u32_u24 v2, 128, v2
    v_add_u32 v2, 131072, v2
    v_cmp_gt_u32 vcc, 16, v3
    s_nop 1
    v_cndmask_b32 v3, 0, 1, vcc
    s_mov_b32 s52, 40000
Lpoll_94:
    buffer_load_dword v1, v2, s[16:19], 0 offen sc1
    s_waitcnt vmcnt(0)
    v_cmp_le_u32 vcc, v3, v1
    s_cmp_eq_u64 vcc, -1
    s_cbranch_scc1 Lpolld_95
    s_sleep 1
    s_sub_u32 s52, s52, 1
    s_cmp_lg_u32 s52, 0
    s_cbranch_scc1 Lpoll_94
Lpolld_95:
Lnopoll_93:
    s_barrier
    s_mov_b32 s56, 0
Lg80xx_96:
    s_add_u32 m0, s56, s58
    s_nop 0
    buffer_load_dwordx4 v10, s[16:19], s54 offen sc1 lds
    buffer_load_dwordx4 v11, s[16:19], s54 offen offset:1024 sc1 lds
    s_add_u32 s54, s54, 262144
    s_add_u32 s56, s56, 18432
    s_cmp_lt_u32 s56, 129024
    s_cbranch_scc1 Lg80xx_96
    s_waitcnt vmcnt(12)
    s_barrier
    s_add_u32 m0, s56, s58
    s_nop 0
    buffer_load_dwordx4 v10, s[16:19], s54 offen sc1 lds
    buffer_load_dwordx4 v11, s[16:19], s54 offen offset:1024 sc1 lds
    s_add_u32 m0, s56, s60
    s_nop 0
    buffer_load_dwordx4 v12, s[16:19], s55 offen offset:0 sc1 lds
    buffer_load_dwordx4 v12, s[16:19], s55 offen offset:1024 sc1 lds
    buffer_load_dwordx4 v12, s[16:19], s55 offen offset:2048 sc1 lds
    s_add_u32 s54, s54, 262144
    s_add_u32 s55, s55, 10240
    s_add_u32 s56, s56, 18432
    s_cmp_eq_u32 s56, 147456
    s_cselect_b32 s56, 0, s56
    s_waitcnt vmcnt(15)
    s_barrier
    s_add_u32 m0, s56, s58
    s_nop 0
    buffer_load_dwordx4 v10, s[16:19], s54 offen sc1 lds
    buffer_load_dwordx4 v11, s[16:19], s54 offen offset:1024 sc1 lds
    s_add_u32 m0, s56, s60
    s_nop 0
    buffer_load_dwordx4 v12, s[16:19], s55 offen offset:0 sc1 lds
    buffer_load_dwordx4 v12, s[16:19], s55 offen offset:1024 sc1 lds
    buffer_load_dwordx4 v12, s[16:19], s55 offen offset:2048 sc1 lds
    s_add_u32 s54, s54, 262144
    s_add_u32 s55, s55, 10240
    s_add_u32 s56, s56, 18432
    s_cmp_eq_u32 s56, 147456
    s_cselect_b32 s56, 0, s56
    s_waitcnt vmcnt(18)
    s_barrier
    s_add_u32 m0, s56, s58
    s_nop 0
    buffer_load_dwordx4 v10, s[16:19], s54 offen sc1 lds
    buffer_load_dwordx4 v11, s[16:19], s54 offen offset:1024 sc1 lds
    s_add_u32 m0, s56, s60
    s_nop 0
    buffer_load_dwordx4 v12, s[16:19], s55 offen offset:0 sc1 lds
    buffer_load_dwordx4 v12, s[16:19], s55 offen offset:1024 sc1 lds
    buffer_load_dwordx4 v12, s[16:19], s55 offen offset:2048 sc1 lds
    s_add_u32 s54, s54, 262144
    s_add_u32 s55, s55, 10240
    s_add_u32 s56, s56, 18432
    s_cmp_eq_u32 s56, 147456
    s_cselect_b32 s56, 0, s56
    s_waitcnt vmcnt(21)
    s_barrier
    s_waitcnt vmcnt(19)
    s_barrier
    s_waitcnt vmcnt(17)
    s_barrier
    s_waitcnt vmcnt(15)
    s_barrier
    s_waitcnt vmcnt(10)
    s_barrier
    s_waitcnt vmcnt(5)
    s_barrier
    s_waitcnt vmcnt(0)
    s_barrier
    s_barrier
    s_branch Lg80re_91
Lg80rb_90:
    s_mov_b32 s57, 0
Lg80w_97:
    s_add_u32 m0, s56, s60
    s_nop 0
    buffer_load_dwordx4 v12, s[16:19], s55 offen offset:0 sc1 lds
    buffer_load_dwordx4 v12, s[16:19], s55 offen offset:1024 sc1 lds
    s_add_u32 s55, s55, 10240
    s_add_u32 s56, s56, 18432
    s_add_u32 s57, s57, 1
    s_cmp_lt_u32 s57, 7
    s_cbranch_scc1 Lg80w_97
    s_cmp_lg_u32 s30, 0
    s_cbranch_scc1 Lnopoll_98
    v_and_b32 v3, 15, v0
    s_lshl_b32 s52, s28, 6
    s_add_u32 s52, s52, 16
    v_add_u32 v2, s52, v3
    v_mul_u32_u24 v2, 128, v2
    v_add_u32 v2, 131072, v2
    v_cmp_gt_u32 vcc, 16, v3
    s_nop 1
    v_cndmask_b32 v3, 0, 1, vcc
    s_mov_b32 s52, 40000
Lpoll_99:
    buffer_load_dword v1, v2, s[16:19], 0 offen sc1
    s_waitcnt vmcnt(0)
    v_cmp_le_u32 vcc, v3, v1
    s_cmp_eq_u64 vcc, -1
    s_cbranch_scc1 Lpolld_100
    s_sleep 1
    s_sub_u32 s52, s52, 1
    s_cmp_lg_u32 s52, 0
    s_cbranch_scc1 Lpoll_99
Lpolld_100:
Lnopoll_98:
    s_barrier
    s_mov_b32 s56, 0
Lg80xx_101:
    s_add_u32 m0, s56, s58
    s_nop 0
    buffer_load_dwordx4 v10, s[16:19], s54 offen sc1 lds
    buffer_load_dwordx4 v11, s[16:19], s54 offen offset:1024 sc1 lds
    s_add_u32 s54, s54, 262144
    s_add_u32 s56, s56, 18432
    s_cmp_lt_u32 s56, 129024
    s_cbranch_scc1 Lg80xx_101
    s_waitcnt vmcnt(12)
    s_barrier
    s_add_u32 m0, s56, s58
    s_nop 0
    buffer_load_dwordx4 v10, s[16:19], s54 offen sc1 lds
    buffer_load_dwordx4 v11, s[16:19], s54 offen offset:1024 sc1 lds
    s_add_u32 m0, s56, s60
    s_nop 0
    buffer_load_dwordx4 v12, s[16:19], s55 offen offset:0 sc1 lds
    buffer_load_dwordx4 v12, s[16:19], s55 offen offset:1024 sc1 lds
    s_add_u32 s54, s54, 262144
    s_add_u32 s55, s55, 10240
    s_add_u32 s56, s56, 18432
    s_cmp_eq_u32 s56, 147456
    s_cselect_b32 s56, 0, s56
    s_waitcnt vmcnt(14)
    s_barrier
    s_add_u32 m0, s56, s58
    s_nop 0
    buffer_load_dwordx4 v10, s[16:19], s54 offen sc1 lds
    buffer_load_dwordx4 v11, s[16:19], s54 offen offset:1024 sc1 lds
    s_add_u32 m0, s56, s60
    s_nop 0
    buffer_load_dwordx4 v12, s[16:19], s55 offen offset:0 sc1 lds
    buffer_load_dwordx4 v12, s[16:19], s55 offen offset:1024 sc1 lds
    s_add_u32 s54, s54, 262144
    s_add_u32 s55, s55, 10240
    s_add_u32 s56, s56, 18432
    s_cmp_eq_u32 s56, 147456
    s_cselect_b32 s56, 0, s56
    s_waitcnt vmcnt(16)
    s_barrier
    s_add_u32 m0, s56, s58
    s_nop 0
    buffer_load_dwordx4 v10, s[16:19], s54 offen sc1 lds
    buffer_load_dwordx4 v11, s[16:19], s54 offen offset:1024 sc1 lds
    s_add_u32 m0, s56, s60
    s_nop 0
    buffer_load_dwordx4 v12, s[16:19], s55 offen offset:0 sc1 lds
    buffer_load_dwordx4 v12, s[16:19], s55 offen offset:1024 sc1 lds
    s_add_u32 s54, s54, 262144
    s_add_u32 s55, s55, 10240
    s_add_u32 s56, s56, 18432
    s_cmp_eq_u32 s56, 147456
    s_cselect_b32 s56, 0, s56
    s_waitcnt vmcnt(18)
    s_barrier
    s_waitcnt vmcnt(16)
    s_barrier
    s_waitcnt vmcnt(14)
    s_barrier
    s_waitcnt vmcnt(12)
    s_barrier
    s_waitcnt vmcnt(8)
    s_barrier
    s_waitcnt vmcnt(4)
    s_barrier
    s_waitcnt vmcnt(0)
    s_barrier
    s_barrier
Lg80re_91:
    s_cmp_lg_u32 s30, 4
    s_cbranch_scc1 Lnosig_102
    s_lshl_b32 s52, s28, 6
    s_add_u32 s52, s52, s29
    s_add_u32 s52, s52, 32
    s_mul_i32 s52, s52, 128
    s_add_u32 s52, s52, 131072
    v_mov_b32 v1, 1
    s_mov_b64 exec, 1
    buffer_store_dword v1, off, s[16:19], s52 sc1
    s_mov_b64 exec, -1
Lnosig_102:
Lp4_80:
    s_cmp_ge_u32 s29, 14
    s_cbranch_scc1 Lp4aux_103
    s_cmp_ge_u32 s30, 4
    s_cbranch_scc1 Lp4ld_104
    s_and_b32 s54, s30, 1
    s_lshr_b32 s55, s30, 1
    v_and_b32 v1, 31, v0
    s_lshl_b32 s52, s54, 6
    v_add_u32 v2, s52, v1
    v_lshlrev_b32 v2, 4, v2
    v_lshrrev_b32 v4, 5, v0
    v_lshl_add_u32 v43, v4, 11, v2
    v_lshrrev_b32 v1, 4, v0
    v_bfe_u32 v2, v0, 2, 2
    v_and_b32 v3, 3, v0
    v_lshrrev_b32 v4, 1, v1
    v_lshl_add_u32 v4, v4, 3, v2
    v_lshlrev_b32 v4, 8, v4
    v_add_u32 v4, 16384, v4
    v_and_b32 v5, 1, v3
    v_lshl_add_u32 v4, v5, 3, v4
    v_and_b32 v5, 1, v1
    v_lshlrev_b32 v5, 1, v5
    v_lshrrev_b32 v6, 1, v3
    v_add_u32 v5, v5, v6
    s_lshl_b32 s52, s55, 3
    v_add_u32 v5, s52, v5
    v_lshlrev_b32 v6, 2, v2
    v_xor_b32 v5, v5, v6
    v_lshl_add_u32 v44, v5, 4, v4
    v_xor_b32 v45, 64, v44
    v_mov_b32 v64, 0
    v_mov_b32 v65, 0
    v_mov_b32 v66, 0
    v_mov_b32 v67, 0
    v_mov_b32 v68, 0
    v_mov_b32 v69, 0
    v_mov_b32 v70, 0
    v_mov_b32 v71, 0
    v_mov_b32 v72, 0
    v_mov_b32 v73, 0
    v_mov_b32 v74, 0
    v_mov_b32 v75, 0
    v_mov_b32 v76, 0
    v_mov_b32 v77, 0
    v_mov_b32 v78, 0
    v_mov_b32 v79, 0
    v_mov_b32 v80, 0
    v_mov_b32 v81, 0
    v_mov_b32 v82, 0
    v_mov_b32 v83, 0
    v_mov_b32 v84, 0
    v_mov_b32 v85, 0
    v_mov_b32 v86, 0
    v_mov_b32 v87, 0
    v_mov_b32 v88, 0
    v_mov_b32 v89, 0
    v_mov_b32 v90, 0
    v_mov_b32 v91, 0
    v_mov_b32 v92, 0
    v_mov_b32 v93, 0
    v_mov_b32 v94, 0
    v_mov_b32 v95, 0
    v_mov_b32 v96, 0
    v_mov_b32 v97, 0
    v_mov_b32 v98, 0
    v_mov_b32 v99, 0
    v_mov_b32 v100, 0
    v_mov_b32 v101, 0
    v_mov_b32 v102, 0
    v_mov_b32 v103, 0
    v_mov_b32 v104, 0
    v_mov_b32 v105, 0
    v_mov_b32 v106, 0
    v_mov_b32 v107, 0
    v_mov_b32 v108, 0
    v_mov_b32 v109, 0
    v_mov_b32 v110, 0
    v_mov_b32 v111, 0
    v_mov_b32 v112, 0
    v_mov_b32 v113, 0
    v_mov_b32 v114, 0
    v_mov_b32 v115, 0
    v_mov_b32 v116, 0
    v_mov_b32 v117, 0
    v_mov_b32 v118, 0
    v_mov_b32 v119, 0
    v_mov_b32 v120, 0
    v_mov_b32 v121, 0
    v_mov_b32 v122, 0
    v_mov_b32 v123, 0
    v_mov_b32 v124, 0
    v_mov_b32 v125, 0
    v_mov_b32 v126, 0
    v_mov_b32 v127, 0
    v_mov_b32 v128, 0
    v_mov_b32 v129, 0
    v_mov_b32 v130, 0
    v_mov_b32 v131, 0
    v_mov_b32 v132, 0
    v_mov_b32 v133, 0
    v_mov_b32 v134, 0
    v_mov_b32 v135, 0
    v_mov_b32 v136, 0
    v_mov_b32 v137, 0
    v_mov_b32 v138, 0
    v_mov_b32 v139, 0
    v_mov_b32 v140, 0
    v_mov_b32 v141, 0
    v_mov_b32 v142, 0
    v_mov_b32 v143, 0
    v_mov_b32 v144, 0
    v_mov_b32 v145, 0
    v_mov_b32 v146, 0
    v_mov_b32 v147, 0
    v_mov_b32 v148, 0
    v_mov_b32 v149, 0
    v_mov_b32 v150, 0
    v_mov_b32 v151, 0
    v_mov_b32 v152, 0
    v_mov_b32 v153, 0
    v_mov_b32 v154, 0
    v_mov_b32 v155, 0
    v_mov_b32 v156, 0
    v_mov_b32 v157, 0
    v_mov_b32 v158, 0
    v_mov_b32 v159, 0
    v_mov_b32 v160, 0
    v_mov_b32 v161, 0
    v_mov_b32 v162, 0
    v_mov_b32 v163, 0
    v_mov_b32 v164, 0
    v_mov_b32 v165, 0
    v_mov_b32 v166, 0
    v_mov_b32 v167, 0
    v_mov_b32 v168, 0
    v_mov_b32 v169, 0
    v_mov_b32 v170, 0
    v_mov_b32 v171, 0
    v_mov_b32 v172, 0
    v_mov_b32 v173, 0
    v_mov_b32 v174, 0
    v_mov_b32 v175, 0
    v_mov_b32 v176, 0
    v_mov_b32 v177, 0
    v_mov_b32 v178, 0
    v_mov_b32 v179, 0
    v_mov_b32 v180, 0
    v_mov_b32 v181, 0
    v_mov_b32 v182, 0
    v_mov_b32 v183, 0
    v_mov_b32 v184, 0
    v_mov_b32 v185, 0
    v_mov_b32 v186, 0
    v_mov_b32 v187, 0
    v_mov_b32 v188, 0
    v_mov_b32 v189, 0
    v_mov_b32 v190, 0
    v_mov_b32 v191, 0
    s_mov_b32 s56, 0
    s_mov_b32 s57, 0
    v_mov_b32 v40, v43
    v_mov_b32 v41, v44
    v_mov_b32 v42, v45
    s_cmp_lg_u32 s30, 0
    s_cbranch_scc1 Lnopoll_106
    v_and_b32 v3, 15, v0
    s_lshl_b32 s52, s28, 6
    s_add_u32 s52, s52, 32
    v_add_u32 v2, s52, v3
    v_mul_u32_u24 v2, 128, v2
    v_add_u32 v2, 131072, v2
    v_cmp_gt_u32 vcc, 16, v3
    s_nop 1
    v_cndmask_b32 v3, 0, 1, vcc
    s_mov_b32 s52, 40000
Lpoll_107:
    buffer_load_dword v1, v2, s[16:19], 0 offen sc1
    s_waitcnt vmcnt(0)
    v_cmp_le_u32 vcc, v3, v1
    s_cmp_eq_u64 vcc, -1
    s_cbranch_scc1 Lpolld_108
    s_sleep 1
    s_sub_u32 s52, s52, 1
    s_cmp_lg_u32 s52, 0
    s_cbranch_scc1 Lpoll_107
Lpolld_108:
Lnopoll_106:
    s_barrier
    v_lshrrev_b32 v1, 5, v0
    v_lshlrev_b32 v2, 4, v1
    s_lshl_b32 s52, s55, 8
    s_add_u32 s52, s52, 148480
    v_add_u32 v32, s52, v2
    v_and_b32 v5, 31, v0
    s_lshl_b32 s52, s54, 6
    v_add_u32 v6, s52, v5
    v_lshlrev_b32 v6, 3, v6
    v_add_u32 v33, 147456, v6
    v_lshlrev_b32 v7, 15, v1
    v_lshl_add_u32 v34, v5, 4, v7
    s_lshl_b32 s53, s29, 4
    s_lshl_b32 s58, s55, 3
    s_add_u32 s58, s58, s53
    s_lshl_b32 s58, s58, 15
    s_lshl_b32 s53, s28, 7
    s_lshl_b32 s59, s54, 6
    s_add_u32 s53, s53, s59
    s_lshl_b32 s53, s53, 4
    s_add_u32 s53, s53, 19922944
    s_add_u32 s58, s58, s53
    s_barrier
    ds_read_b64_tr_b16 v[200:201], v41 offset:0
    ds_read_b64_tr_b16 v[202:203], v41 offset:1024
    ds_read_b128 v[192:195], v40 offset:0
    ds_read_b128 v[196:199], v40 offset:512
    ds_read_b64_tr_b16 v[204:205], v42 offset:0
    ds_read_b64_tr_b16 v[206:207], v42 offset:1024
    ds_read_b64_tr_b16 v[208:209], v41 offset:16384
    ds_read_b64_tr_b16 v[210:211], v41 offset:17408
    ds_read_b64_tr_b16 v[212:213], v42 offset:16384
    ds_read_b64_tr_b16 v[214:215], v42 offset:17408
Lp4c_109:
    s_waitcnt lgkmcnt(7)
    v_mfma_f32_32x32x16_bf16 v[64:79], v[200:203], v[192:195], v[64:79]
    ds_read_b64_tr_b16 v[224:225], v41 offset:4096
    ds_read_b64_tr_b16 v[226:227], v41 offset:5120
    ds_read_b128 v[216:219], v40 offset:4096
    s_waitcnt lgkmcnt(9)
    v_mfma_f32_32x32x16_bf16 v[80:95], v[200:203], v[196:199], v[80:95]
    ds_read_b128 v[220:223], v40 offset:4608
    ds_read_b64_tr_b16 v[228:229], v42 offset:4096
    ds_read_b64_tr_b16 v[230:231], v42 offset:5120
    s_waitcnt lgkmcnt(10)
    v_mfma_f32_32x32x16_bf16 v[96:111], v[204:207], v[192:195], v[96:111]
    ds_read_b64_tr_b16 v[232:233], v41 offset:20480
    ds_read_b64_tr_b16 v[234:235], v41 offset:21504
    v_mfma_f32_32x32x16_bf16 v[112:127], v[204:207], v[196:199], v[112:127]
    ds_read_b64_tr_b16 v[236:237], v42 offset:20480
    ds_read_b64_tr_b16 v[238:239], v42 offset:21504
    s_waitcnt lgkmcnt(12)
    v_mfma_f32_32x32x16_bf16 v[128:143], v[208:211], v[192:195], v[128:143]
    v_mfma_f32_32x32x16_bf16 v[144:159], v[208:211], v[196:199], v[144:159]
    s_waitcnt lgkmcnt(10)
    v_mfma_f32_32x32x16_bf16 v[160:175], v[212:215], v[192:195], v[160:175]
    v_mfma_f32_32x32x16_bf16 v[176:191], v[212:215], v[196:199], v[176:191]
    s_waitcnt lgkmcnt(7)
    v_mfma_f32_32x32x16_bf16 v[64:79], v[224:227], v[216:219], v[64:79]
    ds_read_b64_tr_b16 v[200:201], v41 offset:8192
    ds_read_b64_tr_b16 v[202:203], v41 offset:9216
    ds_read_b128 v[192:195], v40 offset:8192
    s_waitcnt lgkmcnt(9)
    v_mfma_f32_32x32x16_bf16 v[80:95], v[224:227], v[220:223], v[80:95]
    ds_read_b128 v[196:199], v40 offset:8704
    ds_read_b64_tr_b16 v[204:205], v42 offset:8192
    ds_read_b64_tr_b16 v[206:207], v42 offset:9216
    s_waitcnt lgkmcnt(10)
    v_mfma_f32_32x32x16_bf16 v[96:111], v[228:231], v[216:219], v[96:111]
    ds_read_b64_tr_b16 v[208:209], v41 offset:24576
    ds_read_b64_tr_b16 v[210:211], v41 offset:25600
    v_mfma_f32_32x32x16_bf16 v[112:127], v[228:231], v[220:223], v[112:127]
    ds_read_b64_tr_b16 v[212:213], v42 offset:24576
    ds_read_b64_tr_b16 v[214:215], v42 offset:25600
    s_waitcnt lgkmcnt(12)
    v_mfma_f32_32x32x16_bf16 v[128:143], v[232:235], v[216:219], v[128:143]
    v_mfma_f32_32x32x16_bf16 v[144:159], v[232:235], v[220:223], v[144:159]
    s_waitcnt lgkmcnt(10)
    v_mfma_f32_32x32x16_bf16 v[160:175], v[236:239], v[216:219], v[160:175]
    v_mfma_f32_32x32x16_bf16 v[176:191], v[236:239], v[220:223], v[176:191]
    s_waitcnt lgkmcnt(7)
    v_mfma_f32_32x32x16_bf16 v[64:79], v[200:203], v[192:195], v[64:79]
    ds_read_b64_tr_b16 v[224:225], v41 offset:12288
    ds_read_b64_tr_b16 v[226:227], v41 offset:13312
    ds_read_b128 v[216:219], v40 offset:12288
    s_waitcnt lgkmcnt(9)
    v_mfma_f32_32x32x16_bf16 v[80:95], v[200:203], v[196:199], v[80:95]
    ds_read_b128 v[220:223], v40 offset:12800
    ds_read_b64_tr_b16 v[228:229], v42 offset:12288
    ds_read_b64_tr_b16 v[230:231], v42 offset:13312
    s_waitcnt lgkmcnt(10)
    v_mfma_f32_32x32x16_bf16 v[96:111], v[204:207], v[192:195], v[96:111]
    ds_read_b64_tr_b16 v[232:233], v41 offset:28672
    ds_read_b64_tr_b16 v[234:235], v41 offset:29696
    v_mfma_f32_32x32x16_bf16 v[112:127], v[204:207], v[196:199], v[112:127]
    ds_read_b64_tr_b16 v[236:237], v42 offset:28672
    ds_read_b64_tr_b16 v[238:239], v42 offset:29696
    s_waitcnt lgkmcnt(12)
    v_mfma_f32_32x32x16_bf16 v[128:143], v[208:211], v[192:195], v[128:143]
    v_mfma_f32_32x32x16_bf16 v[144:159], v[208:211], v[196:199], v[144:159]
    s_waitcnt lgkmcnt(10)
    v_mfma_f32_32x32x16_bf16 v[160:175], v[212:215], v[192:195], v[160:175]
    v_mfma_f32_32x32x16_bf16 v[176:191], v[212:215], v[196:199], v[176:191]
    s_add_u32 s56, s56, 49152
    s_cmp_eq_u32 s56, 147456
    s_cselect_b32 s56, 0, s56
    s_add_u32 s57, s57, 1
    s_waitcnt lgkmcnt(0)
    v_add_u32 v40, s56, v43
    v_add_u32 v41, s56, v44
    v_add_u32 v42, s56, v45
    s_cmp_eq_u32 s57, 10
    s_cbranch_scc1 Lp4tail_111
    s_barrier
    v_mfma_f32_32x32x16_bf16 v[64:79], v[224:227], v[216:219], v[64:79]
    ds_read_b64_tr_b16 v[200:201], v41 offset:0
    ds_read_b64_tr_b16 v[202:203], v41 offset:1024
    ds_read_b128 v[192:195], v40 offset:0
    v_mfma_f32_32x32x16_bf16 v[80:95], v[224:227], v[220:223], v[80:95]
    ds_read_b128 v[196:199], v40 offset:512
    ds_read_b64_tr_b16 v[204:205], v42 offset:0
    ds_read_b64_tr_b16 v[206:207], v42 offset:1024
    v_mfma_f32_32x32x16_bf16 v[96:111], v[228:231], v[216:219], v[96:111]
    ds_read_b64_tr_b16 v[208:209], v41 offset:16384
    ds_read_b64_tr_b16 v[210:211], v41 offset:17408
    v_mfma_f32_32x32x16_bf16 v[112:127], v[228:231], v[220:223], v[112:127]
    ds_read_b64_tr_b16 v[212:213], v42 offset:16384
    ds_read_b64_tr_b16 v[214:215], v42 offset:17408
    v_mfma_f32_32x32x16_bf16 v[128:143], v[232:235], v[216:219], v[128:143]
    v_mfma_f32_32x32x16_bf16 v[144:159], v[232:235], v[220:223], v[144:159]
    v_mfma_f32_32x32x16_bf16 v[160:175], v[236:239], v[216:219], v[160:175]
    v_mfma_f32_32x32x16_bf16 v[176:191], v[236:239], v[220:223], v[176:191]
    s_branch Lp4c_109
Lp4tail_111:
    s_barrier
    ds_read_b64 v[8:9], v33
    ds_read_b64 v[10:11], v33 offset:256
    ds_read_b128 v[192:195], v32 offset:0
    ds_read_b128 v[12:15], v32 offset:512
    ds_read_b128 v[196:199], v32 offset:32
    ds_read_b128 v[16:19], v32 offset:544
    ds_read_b128 v[200:203], v32 offset:64
    ds_read_b128 v[20:23], v32 offset:576
    ds_read_b128 v[204:207], v32 offset:96
    ds_read_b128 v[24:27], v32 offset:608
    v_mfma_f32_32x32x16_bf16 v[64:79], v[224:227], v[216:219], v[64:79]
    v_mfma_f32_32x32x16_bf16 v[128:143], v[232:235], v[216:219], v[128:143]
    v_mfma_f32_32x32x16_bf16 v[80:95], v[224:227], v[220:223], v[80:95]
    v_mfma_f32_32x32x16_bf16 v[144:159], v[232:235], v[220:223], v[144:159]
    v_mfma_f32_32x32x16_bf16 v[96:111], v[228:231], v[216:219], v[96:111]
    v_mfma_f32_32x32x16_bf16 v[160:175], v[236:239], v[216:219], v[160:175]
    v_mfma_f32_32x32x16_bf16 v[112:127], v[228:231], v[220:223], v[112:127]
    v_mfma_f32_32x32x16_bf16 v[176:191], v[236:239], v[220:223], v[176:191]
    ds_read_b128 v[28:31], v32 offset:640
    ds_read_b128 v[36:39], v32 offset:672
    ds_read_b128 v[240:243], v32 offset:704
    ds_read_b128 v[244:247], v32 offset:736
    s_waitcnt lgkmcnt(4)
    v_pk_fma_f32 v[64:65], v[192:193], v[8:9], v[64:65] op_sel_hi:[1,0,1]
    v_pk_fma_f32 v[128:129], v[12:13], v[8:9], v[128:129] op_sel_hi:[1,0,1]
    v_pk_fma_f32 v[66:67], v[194:195], v[8:9], v[66:67] op_sel_hi:[1,0,1]
    v_pk_fma_f32 v[130:131], v[14:15], v[8:9], v[130:131] op_sel_hi:[1,0,1]
    v_pk_mul_f32 v[64:65], v[64:65], v[8:9] op_sel:[0,1] op_sel_hi:[1,1]
    v_pk_mul_f32 v[66:67], v[66:67], v[8:9] op_sel:[0,1] op_sel_hi:[1,1]
    v_pk_mul_f32 v[64:65], v[64:65], v[128:129]
    v_pk_mul_f32 v[66:67], v[66:67], v[130:131]
    v_cvt_pk_bf16_f32 v224, v64, v65
    v_cvt_pk_bf16_f32 v225, v66, v67
    v_pk_fma_f32 v[68:69], v[196:197], v[8:9], v[68:69] op_sel_hi:[1,0,1]
    v_pk_fma_f32 v[132:133], v[16:17], v[8:9], v[132:133] op_sel_hi:[1,0,1]
    v_pk_fma_f32 v[70:71], v[198:199], v[8:9], v[70:71] op_sel_hi:[1,0,1]
    v_pk_fma_f32 v[134:135], v[18:19], v[8:9], v[134:135] op_sel_hi:[1,0,1]
    v_pk_mul_f32 v[68:69], v[68:69], v[8:9] op_sel:[0,1] op_sel_hi:[1,1]
    v_pk_mul_f32 v[70:71], v[70:71], v[8:9] op_sel:[0,1] op_sel_hi:[1,1]
    v_pk_mul_f32 v[68:69], v[68:69], v[132:133]
    v_pk_mul_f32 v[70:71], v[70:71], v[134:135]
    v_cvt_pk_bf16_f32 v226, v68, v69
    v_cvt_pk_bf16_f32 v227, v70, v71
    s_nop 0
    v_permlane32_swap_b32 v224, v226
    v_permlane32_swap_b32 v225, v227
    s_add_u32 s57, s58, 0
    buffer_store_dwordx4 v[224:227], v34, s[16:19], s57 offen sc1
    ds_read_b128 v[208:211], v32 offset:128
    ds_read_b128 v[212:215], v32 offset:160
    ds_read_b128 v[216:219], v32 offset:192
    ds_read_b128 v[220:223], v32 offset:224
    v_pk_fma_f32 v[72:73], v[200:201], v[8:9], v[72:73] op_sel_hi:[1,0,1]
    v_pk_fma_f32 v[136:137], v[20:21], v[8:9], v[136:137] op_sel_hi:[1,0,1]
    v_pk_fma_f32 v[74:75], v[202:203], v[8:9], v[74:75] op_sel_hi:[1,0,1]
    v_pk_fma_f32 v[138:139], v[22:23], v[8:9], v[138:139] op_sel_hi:[1,0,1]
    v_pk_mul_f32 v[72:73], v[72:73], v[8:9] op_sel:[0,1] op_sel_hi:[1,1]
    v_pk_mul_f32 v[74:75], v[74:75], v[8:9] op_sel:[0,1] op_sel_hi:[1,1]
    v_pk_mul_f32 v[72:73], v[72:73], v[136:137]
    v_pk_mul_f32 v[74:75], v[74:75], v[138:139]
    v_cvt_pk_bf16_f32 v228, v72, v73
    v_cvt_pk_bf16_f32 v229, v74, v75
    v_pk_fma_f32 v[76:77], v[204:205], v[8:9], v[76:77] op_sel_hi:[1,0,1]
    v_pk_fma_f32 v[140:141], v[24:25], v[8:9], v[140:141] op_sel_hi:[1,0,1]
    v_pk_fma_f32 v[78:79], v[206:207], v[8:9], v[78:79] op_sel_hi:[1,0,1]
    v_pk_fma_f32 v[142:143], v[26:27], v[8:9], v[142:143] op_sel_hi:[1,0,1]
    v_pk_mul_f32 v[76:77], v[76:77], v[8:9] op_sel:[0,1] op_sel_hi:[1,1]
    v_pk_mul_f32 v[78:79], v[78:79], v[8:9] op_sel:[0,1] op_sel_hi:[1,1]
    v_pk_mul_f32 v[76:77], v[76:77], v[140:141]
    v_pk_mul_f32 v[78:79], v[78:79], v[142:143]
    v_cvt_pk_bf16_f32 v230, v76, v77
    v_cvt_pk_bf16_f32 v231, v78, v79
    s_nop 0
    v_permlane32_swap_b32 v228, v230
    v_permlane32_swap_b32 v229, v231
    s_add_u32 s57, s58, 65536
    buffer_store_dwordx4 v[228:231], v34, s[16:19], s57 offen sc1
    v_pk_fma_f32 v[80:81], v[192:193], v[10:11], v[80:81] op_sel_hi:[1,0,1]
    v_pk_fma_f32 v[144:145], v[12:13], v[10:11], v[144:145] op_sel_hi:[1,0,1]
    v_pk_fma_f32 v[82:83], v[194:195], v[10:11], v[82:83] op_sel_hi:[1,0,1]
    v_pk_fma_f32 v[146:147], v[14:15], v[10:11], v[146:147] op_sel_hi:[1,0,1]
    v_pk_mul_f32 v[80:81], v[80:81], v[10:11] op_sel:[0,1] op_sel_hi:[1,1]
    v_pk_mul_f32 v[82:83], v[82:83], v[10:11] op_sel:[0,1] op_sel_hi:[1,1]
    v_pk_mul_f32 v[80:81], v[80:81], v[144:145]
    v_pk_mul_f32 v[82:83], v[82:83], v[146:147]
    v_cvt_pk_bf16_f32 v232, v80, v81
    v_cvt_pk_bf16_f32 v233, v82, v83
    v_pk_fma_f32 v[84:85], v[196:197], v[10:11], v[84:85] op_sel_hi:[1,0,1]
    v_pk_fma_f32 v[148:149], v[16:17], v[10:11], v[148:149] op_sel_hi:[1,0,1]
    v_pk_fma_f32 v[86:87], v[198:199], v[10:11], v[86:87] op_sel_hi:[1,0,1]
    v_pk_fma_f32 v[150:151], v[18:19], v[10:11], v[150:151] op_sel_hi:[1,0,1]
    v_pk_mul_f32 v[84:85], v[84:85], v[10:11] op_sel:[0,1] op_sel_hi:[1,1]
    v_pk_mul_f32 v[86:87], v[86:87], v[10:11] op_sel:[0,1] op_sel_hi:[1,1]
    v_pk_mul_f32 v[84:85], v[84:85], v[148:149]
    v_pk_mul_f32 v[86:87], v[86:87], v[150:151]
    v_cvt_pk_bf16_f32 v234, v84, v85
    v_cvt_pk_bf16_f32 v235, v86, v87
    s_nop 0
    v_permlane32_swap_b32 v232, v234
    v_permlane32_swap_b32 v233, v235
    s_add_u32 s57, s58, 512
    buffer_store_dwordx4 v[232:235], v34, s[16:19], s57 offen sc1
    v_pk_fma_f32 v[88:89], v[200:201], v[10:11], v[88:89] op_sel_hi:[1,0,1]
    v_pk_fma_f32 v[152:153], v[20:21], v[10:11], v[152:153] op_sel_hi:[1,0,1]
    v_pk_fma_f32 v[90:91], v[202:203], v[10:11], v[90:91] op_sel_hi:[1,0,1]
    v_pk_fma_f32 v[154:155], v[22:23], v[10:11], v[154:155] op_sel_hi:[1,0,1]
    v_pk_mul_f32 v[88:89], v[88:89], v[10:11] op_sel:[0,1] op_sel_hi:[1,1]
    v_pk_mul_f32 v[90:91], v[90:91], v[10:11] op_sel:[0,1] op_sel_hi:[1,1]
    v_pk_mul_f32 v[88:89], v[88:89], v[152:153]
    v_pk_mul_f32 v[90:91], v[90:91], v[154:155]
    v_cvt_pk_bf16_f32 v236, v88, v89
    v_cvt_pk_bf16_f32 v237, v90, v91
    v_pk_fma_f32 v[92:93], v[204:205], v[10:11], v[92:93] op_sel_hi:[1,0,1]
    v_pk_fma_f32 v[156:157], v[24:25], v[10:11], v[156:157] op_sel_hi:[1,0,1]
    v_pk_fma_f32 v[94:95], v[206:207], v[10:11], v[94:95] op_sel_hi:[1,0,1]
    v_pk_fma_f32 v[158:159], v[26:27], v[10:11], v[158:159] op_sel_hi:[1,0,1]
    v_pk_mul_f32 v[92:93], v[92:93], v[10:11] op_sel:[0,1] op_sel_hi:[1,1]
    v_pk_mul_f32 v[94:95], v[94:95], v[10:11] op_sel:[0,1] op_sel_hi:[1,1]
    v_pk_mul_f32 v[92:93], v[92:93], v[156:157]
    v_pk_mul_f32 v[94:95], v[94:95], v[158:159]
    v_cvt_pk_bf16_f32 v238, v92, v93
    v_cvt_pk_bf16_f32 v239, v94, v95
    s_nop 0
    v_permlane32_swap_b32 v236, v238
    v_permlane32_swap_b32 v237, v239
    s_add_u32 s57, s58, 66048
    buffer_store_dwordx4 v[236:239], v34, s[16:19], s57 offen sc1
    s_waitcnt lgkmcnt(0)
    v_pk_fma_f32 v[96:97], v[208:209], v[8:9], v[96:97] op_sel_hi:[1,0,1]
    v_pk_fma_f32 v[160:161], v[28:29], v[8:9], v[160:161] op_sel_hi:[1,0,1]
    v_pk_fma_f32 v[98:99], v[210:211], v[8:9], v[98:99] op_sel_hi:[1,0,1]
    v_pk_fma_f32 v[162:163], v[30:31], v[8:9], v[162:163] op_sel_hi:[1,0,1]
    v_pk_mul_f32 v[96:97], v[96:97], v[8:9] op_sel:[0,1] op_sel_hi:[1,1]
    v_pk_mul_f32 v[98:99], v[98:99], v[8:9] op_sel:[0,1] op_sel_hi:[1,1]
    v_pk_mul_f32 v[96:97], v[96:97], v[160:161]
    v_pk_mul_f32 v[98:99], v[98:99], v[162:163]
    v_cvt_pk_bf16_f32 v224, v96, v97
    v_cvt_pk_bf16_f32 v225, v98, v99
    v_pk_fma_f32 v[100:101], v[212:213], v[8:9], v[100:101] op_sel_hi:[1,0,1]
    v_pk_fma_f32 v[164:165], v[36:37], v[8:9], v[164:165] op_sel_hi:[1,0,1]
    v_pk_fma_f32 v[102:103], v[214:215], v[8:9], v[102:103] op_sel_hi:[1,0,1]
    v_pk_fma_f32 v[166:167], v[38:39], v[8:9], v[166:167] op_sel_hi:[1,0,1]
    v_pk_mul_f32 v[100:101], v[100:101], v[8:9] op_sel:[0,1] op_sel_hi:[1,1]
    v_pk_mul_f32 v[102:103], v[102:103], v[8:9] op_sel:[0,1] op_sel_hi:[1,1]
    v_pk_mul_f32 v[100:101], v[100:101], v[164:165]
    v_pk_mul_f32 v[102:103], v[102:103], v[166:167]
    v_cvt_pk_bf16_f32 v226, v100, v101
    v_cvt_pk_bf16_f32 v227, v102, v103
    s_nop 0
    v_permlane32_swap_b32 v224, v226
    v_permlane32_swap_b32 v225, v227
    s_add_u32 s57, s58, 131072
    buffer_store_dwordx4 v[224:227], v34, s[16:19], s57 offen sc1
    v_pk_fma_f32 v[104:105], v[216:217], v[8:9], v[104:105] op_sel_hi:[1,0,1]
    v_pk_fma_f32 v[168:169], v[240:241], v[8:9], v[168:169] op_sel_hi:[1,0,1]
    v_pk_fma_f32 v[106:107], v[218:219], v[8:9], v[106:107] op_sel_hi:[1,0,1]
    v_pk_fma_f32 v[170:171], v[242:243], v[8:9], v[170:171] op_sel_hi:[1,0,1]
    v_pk_mul_f32 v[104:105], v[104:105], v[8:9] op_sel:[0,1] op_sel_hi:[1,1]
    v_pk_mul_f32 v[106:107], v[106:107], v[8:9] op_sel:[0,1] op_sel_hi:[1,1]
    v_pk_mul_f32 v[104:105], v[104:105], v[168:169]
    v_pk_mul_f32 v[106:107], v[106:107], v[170:171]
    v_cvt_pk_bf16_f32 v228, v104, v105
    v_cvt_pk_bf16_f32 v229, v106, v107
    v_pk_fma_f32 v[108:109], v[220:221], v[8:9], v[108:109] op_sel_hi:[1,0,1]
    v_pk_fma_f32 v[172:173], v[244:245], v[8:9], v[172:173] op_sel_hi:[1,0,1]
    v_pk_fma_f32 v[110:111], v[222:223], v[8:9], v[110:111] op_sel_hi:[1,0,1]
    v_pk_fma_f32 v[174:175], v[246:247], v[8:9], v[174:175] op_sel_hi:[1,0,1]
    v_pk_mul_f32 v[108:109], v[108:109], v[8:9] op_sel:[0,1] op_sel_hi:[1,1]
    v_pk_mul_f32 v[110:111], v[110:111], v[8:9] op_sel:[0,1] op_sel_hi:[1,1]
    v_pk_mul_f32 v[108:109], v[108:109], v[172:173]
    v_pk_mul_f32 v[110:111], v[110:111], v[174:175]
    v_cvt_pk_bf16_f32 v230, v108, v109
    v_cvt_pk_bf16_f32 v231, v110, v111
    s_nop 0
    v_permlane32_swap_b32 v228, v230
    v_permlane32_swap_b32 v229, v231
    s_add_u32 s57, s58, 196608
    buffer_store_dwordx4 v[228:231], v34, s[16:19], s57 offen sc1
    v_pk_fma_f32 v[112:113], v[208:209], v[10:11], v[112:113] op_sel_hi:[1,0,1]
    v_pk_fma_f32 v[176:177], v[28:29], v[10:11], v[176:177] op_sel_hi:[1,0,1]
    v_pk_fma_f32 v[114:115], v[210:211], v[10:11], v[114:115] op_sel_hi:[1,0,1]
    v_pk_fma_f32 v[178:179], v[30:31], v[10:11], v[178:179] op_sel_hi:[1,0,1]
    v_pk_mul_f32 v[112:113], v[112:113], v[10:11] op_sel:[0,1] op_sel_hi:[1,1]
    v_pk_mul_f32 v[114:115], v[114:115], v[10:11] op_sel:[0,1] op_sel_hi:[1,1]
    v_pk_mul_f32 v[112:113], v[112:113], v[176:177]
    v_pk_mul_f32 v[114:115], v[114:115], v[178:179]
    v_cvt_pk_bf16_f32 v232, v112, v113
    v_cvt_pk_bf16_f32 v233, v114, v115
    v_pk_fma_f32 v[116:117], v[212:213], v[10:11], v[116:117] op_sel_hi:[1,0,1]
    v_pk_fma_f32 v[180:181], v[36:37], v[10:11], v[180:181] op_sel_hi:[1,0,1]
    v_pk_fma_f32 v[118:119], v[214:215], v[10:11], v[118:119] op_sel_hi:[1,0,1]
    v_pk_fma_f32 v[182:183], v[38:39], v[10:11], v[182:183] op_sel_hi:[1,0,1]
    v_pk_mul_f32 v[116:117], v[116:117], v[10:11] op_sel:[0,1] op_sel_hi:[1,1]
    v_pk_mul_f32 v[118:119], v[118:119], v[10:11] op_sel:[0,1] op_sel_hi:[1,1]
    v_pk_mul_f32 v[116:117], v[116:117], v[180:181]
    v_pk_mul_f32 v[118:119], v[118:119], v[182:183]
    v_cvt_pk_bf16_f32 v234, v116, v117
    v_cvt_pk_bf16_f32 v235, v118, v119
    s_nop 0
    v_permlane32_swap_b32 v232, v234
    v_permlane32_swap_b32 v233, v235
    s_add_u32 s57, s58, 131584
    buffer_store_dwordx4 v[232:235], v34, s[16:19], s57 offen sc1
    v_pk_fma_f32 v[120:121], v[216:217], v[10:11], v[120:121] op_sel_hi:[1,0,1]
    v_pk_fma_f32 v[184:185], v[240:241], v[10:11], v[184:185] op_sel_hi:[1,0,1]
    v_pk_fma_f32 v[122:123], v[218:219], v[10:11], v[122:123] op_sel_hi:[1,0,1]
    v_pk_fma_f32 v[186:187], v[242:243], v[10:11], v[186:187] op_sel_hi:[1,0,1]
    v_pk_mul_f32 v[120:121], v[120:121], v[10:11] op_sel:[0,1] op_sel_hi:[1,1]
    v_pk_mul_f32 v[122:123], v[122:123], v[10:11] op_sel:[0,1] op_sel_hi:[1,1]
    v_pk_mul_f32 v[120:121], v[120:121], v[184:185]
    v_pk_mul_f32 v[122:123], v[122:123], v[186:187]
    v_cvt_pk_bf16_f32 v236, v120, v121
    v_cvt_pk_bf16_f32 v237, v122, v123
    v_pk_fma_f32 v[124:125], v[220:221], v[10:11], v[124:125] op_sel_hi:[1,0,1]
    v_pk_fma_f32 v[188:189], v[244:245], v[10:11], v[188:189] op_sel_hi:[1,0,1]
    v_pk_fma_f32 v[126:127], v[222:223], v[10:11], v[126:127] op_sel_hi:[1,0,1]
    v_pk_fma_f32 v[190:191], v[246:247], v[10:11], v[190:191] op_sel_hi:[1,0,1]
    v_pk_mul_f32 v[124:125], v[124:125], v[10:11] op_sel:[0,1] op_sel_hi:[1,1]
    v_pk_mul_f32 v[126:127], v[126:127], v[10:11] op_sel:[0,1] op_sel_hi:[1,1]
    v_pk_mul_f32 v[124:125], v[124:125], v[188:189]
    v_pk_mul_f32 v[126:127], v[126:127], v[190:191]
    v_cvt_pk_bf16_f32 v238, v124, v125
    v_cvt_pk_bf16_f32 v239, v126, v127
    s_nop 0
    v_permlane32_swap_b32 v236, v238
    v_permlane32_swap_b32 v237, v239
    s_add_u32 s57, s58, 197120
    buffer_store_dwordx4 v[236:239], v34, s[16:19], s57 offen sc1
    s_waitcnt vmcnt(0)
    s_barrier
    s_branch Lp5_105
Lp4ld_104:
    s_sub_u32 s31, s30, 4
    s_mov_b32 s8, s40
    s_and_b32 s9, s41, 0xffff
    s_mov_b32 s10, 2211840
    s_mov_b32 s11, 0x20000
    s_mov_b32 s12, s42
    s_and_b32 s13, s43, 0xffff
    s_mov_b32 s14, 2211840
    s_mov_b32 s15, 0x20000
    v_lshlrev_b32 v10, 4, v0
    v_add_u32 v11, 30720, v10
    v_lshrrev_b32 v2, 4, v0
    s_lshl_b32 s52, s31, 4
    v_add_u32 v4, s52, v2
    v_mul_u32_u24 v4, 3456, v4
    v_and_b32 v5, 15, v0
    v_lshlrev_b32 v6, 2, v2
    v_xor_b32 v5, v5, v6
    v_lshl_add_u32 v14, v5, 4, v4
    v_add_u32 v15, 12800, v14
    v_add_u32 v16, 25600, v14
    v_add_u32 v17, 38400, v14
    s_lshl_b32 s54, s31, 16
    s_lshl_b32 s52, s28, 11
    s_add_u32 s54, s54, s52
    s_add_u32 s54, s54, 16777216
    s_lshl_b32 s55, s29, 8
    s_lshl_b32 s58, s31, 12
    s_mov_b32 s56, s58
    s_add_u32 s59, s58, 147456
    s_add_u32 m0, s56, 16384
    s_nop 0
    buffer_load_dwordx4 v14, s[8:11], s55 offen offset:0 lds
    buffer_load_dwordx4 v15, s[8:11], s55 offen offset:1024 lds
    buffer_load_dwordx4 v16, s[8:11], s55 offen offset:2048 lds
    buffer_load_dwordx4 v17, s[8:11], s55 offen offset:3072 lds
    s_add_u32 m0, s56, 32768
    s_nop 0
    buffer_load_dwordx4 v14, s[12:15], s55 offen offset:0 lds
    buffer_load_dwordx4 v15, s[12:15], s55 offen offset:1024 lds
    buffer_load_dwordx4 v16, s[12:15], s55 offen offset:2048 lds
    buffer_load_dwordx4 v17, s[12:15], s55 offen offset:3072 lds
    s_add_u32 s55, s55, 221184
    s_add_u32 s56, s56, 49152
    s_cmp_eq_u32 s56, s59
    s_cselect_b32 s56, s58, s56
    s_add_u32 m0, s56, 16384
    s_nop 0
    buffer_load_dwordx4 v14, s[8:11], s55 offen offset:0 lds
    buffer_load_dwordx4 v15, s[8:11], s55 offen offset:1024 lds
    buffer_load_dwordx4 v16, s[8:11], s55 offen offset:2048 lds
    buffer_load_dwordx4 v17, s[8:11], s55 offen offset:3072 lds
    s_add_u32 m0, s56, 32768
    s_nop 0
    buffer_load_dwordx4 v14, s[12:15], s55 offen offset:0 lds
    buffer_load_dwordx4 v15, s[12:15], s55 offen offset:1024 lds
    buffer_load_dwordx4 v16, s[12:15], s55 offen offset:2048 lds
    buffer_load_dwordx4 v17, s[12:15], s55 offen offset:3072 lds
    s_add_u32 s55, s55, 221184
    s_add_u32 s56, s56, 49152
    s_cmp_eq_u32 s56, s59
    s_cselect_b32 s56, s58, s56
    s_cmp_lg_u32 s30, 0
    s_cbranch_scc1 Lnopoll_112
    v_and_b32 v3, 15, v0
    s_lshl_b32 s52, s28, 6
    s_add_u32 s52, s52, 32
    v_add_u32 v2, s52, v3
    v_mul_u32_u24 v2, 128, v2
    v_add_u32 v2, 131072, v2
    v_cmp_gt_u32 vcc, 16, v3
    s_nop 1
    v_cndmask_b32 v3, 0, 1, vcc
    s_mov_b32 s52, 40000
Lpoll_113:
    buffer_load_dword v1, v2, s[16:19], 0 offen sc1
    s_waitcnt vmcnt(0)
    v_cmp_le_u32 vcc, v3, v1
    s_cmp_eq_u64 vcc, -1
    s_cbranch_scc1 Lpolld_114
    s_sleep 1
    s_sub_u32 s52, s52, 1
    s_cmp_lg_u32 s52, 0
    s_cbranch_scc1 Lpoll_113
Lpolld_114:
Lnopoll_112:
    s_barrier
    s_mov_b32 s56, s58
    s_mov_b32 m0, s56
    s_nop 0
    buffer_load_dwordx4 v10, s[16:19], s54 offen offset:0 sc1 lds
    buffer_load_dwordx4 v10, s[16:19], s54 offen offset:1024 sc1 lds
    buffer_load_dwordx4 v11, s[16:19], s54 offen offset:2048 sc1 lds
    buffer_load_dwordx4 v11, s[16:19], s54 offen offset:3072 sc1 lds
    s_add_u32 s54, s54, 262144
    s_add_u32 s56, s56, 49152
    s_cmp_eq_u32 s56, s59
    s_cselect_b32 s56, s58, s56
    s_mov_b32 m0, s56
    s_nop 0
    buffer_load_dwordx4 v10, s[16:19], s54 offen offset:0 sc1 lds
    buffer_load_dwordx4 v10, s[16:19], s54 offen offset:1024 sc1 lds
    buffer_load_dwordx4 v11, s[16:19], s54 offen offset:2048 sc1 lds
    buffer_load_dwordx4 v11, s[16:19], s54 offen offset:3072 sc1 lds
    s_add_u32 s54, s54, 262144
    s_add_u32 s56, s56, 49152
    s_cmp_eq_u32 s56, s59
    s_cselect_b32 s56, s58, s56
    s_cmp_ge_u32 s31, 2
    s_cbranch_scc1 Lroleb_115
    s_lshl_b32 s52, s28, 7
    s_lshl_b32 s53, s31, 6
    s_add_u32 s52, s52, s53
    s_lshl_b32 s52, s52, 3
    s_add_u32 s52, s52, 524288
    v_lshlrev_b32 v2, 3, v0
    buffer_load_dwordx2 v[24:25], v2, s[16:19], s52 offen sc1
    s_add_u32 s52, s52, 16384
    buffer_load_dwordx2 v[26:27], v2, s[16:19], s52 offen sc1
    s_add_u32 s52, s52, 16384
    buffer_load_dwordx2 v[28:29], v2, s[16:19], s52 offen sc1
    s_add_u32 s52, s52, 16384
    buffer_load_dwordx2 v[30:31], v2, s[16:19], s52 offen sc1
    s_add_u32 s52, s52, 16384
    buffer_load_dwordx2 v[32:33], v2, s[16:19], s52 offen sc1
    s_add_u32 s52, s52, 16384
    buffer_load_dwordx2 v[34:35], v2, s[16:19], s52 offen sc1
    s_add_u32 s52, s52, 16384
    buffer_load_dwordx2 v[36:37], v2, s[16:19], s52 offen sc1
    s_add_u32 s52, s52, 16384
    buffer_load_dwordx2 v[38:39], v2, s[16:19], s52 offen sc1
    s_add_u32 s52, s52, 16384
    buffer_load_dwordx2 v[40:41], v2, s[16:19], s52 offen sc1
    s_add_u32 s52, s52, 16384
    buffer_load_dwordx2 v[42:43], v2, s[16:19], s52 offen sc1
    s_add_u32 s52, s52, 16384
    buffer_load_dwordx2 v[44:45], v2, s[16:19], s52 offen sc1
    s_add_u32 s52, s52, 16384
    buffer_load_dwordx2 v[46:47], v2, s[16:19], s52 offen sc1
    s_add_u32 s52, s52, 16384
    buffer_load_dwordx2 v[48:49], v2, s[16:19], s52 offen sc1
    s_add_u32 s52, s52, 16384
    buffer_load_dwordx2 v[50:51], v2, s[16:19], s52 offen sc1
    s_add_u32 s52, s52, 16384
    buffer_load_dwordx2 v[52:53], v2, s[16:19], s52 offen sc1
    s_add_u32 s52, s52, 16384
    buffer_load_dwordx2 v[54:55], v2, s[16:19], s52 offen sc1
    s_mov_b32 s61, 805306394
    s_mov_b32 s62, 2
    s_branch Lp4go_117
Lroleb_115:
    s_mov_b32 s61, 142606337
    s_mov_b32 s62, 6
    s_mov_b32 s64, 0
    s_sub_u32 s52, s31, 2
    s_lshl_b32 s53, s52, 13
    s_lshl_b32 s63, s29, 9
    s_add_u32 s63, s63, s53
    s_add_u32 s63, s63, 65536
    v_lshlrev_b32 v2, 3, v0
    v_mov_b32 v3, 16896
Lp4go_117:
    s_mov_b32 s57, 0
Lp4l_116:
    s_and_b32 s52, s61, 7
    s_lshr_b32 s61, s61, 3
    s_cmp_lg_u32 s52, 0
    s_cbranch_scc1 Lw4_123
    s_waitcnt vmcnt(12)
Lwd_118:
    s_barrier
    s_cmp_lt_u32 s57, 8
    s_cbranch_scc0 Lni_119
    s_mov_b32 m0, s56
    s_nop 0
    buffer_load_dwordx4 v10, s[16:19], s54 offen offset:0 sc1 lds
    buffer_load_dwordx4 v10, s[16:19], s54 offen offset:1024 sc1 lds
    buffer_load_dwordx4 v11, s[16:19], s54 offen offset:2048 sc1 lds
    buffer_load_dwordx4 v11, s[16:19], s54 offen offset:3072 sc1 lds
    s_add_u32 m0, s56, 16384
    s_nop 0
    buffer_load_dwordx4 v14, s[8:11], s55 offen offset:0 lds
    buffer_load_dwordx4 v15, s[8:11], s55 offen offset:1024 lds
    buffer_load_dwordx4 v16, s[8:11], s55 offen offset:2048 lds
    buffer_load_dwordx4 v17, s[8:11], s55 offen offset:3072 lds
    s_add_u32 m0, s56, 32768
    s_nop 0
    buffer_load_dwordx4 v14, s[12:15], s55 offen offset:0 lds
    buffer_load_dwordx4 v15, s[12:15], s55 offen offset:1024 lds
    buffer_load_dwordx4 v16, s[12:15], s55 offen offset:2048 lds
    buffer_load_dwordx4 v17, s[12:15], s55 offen offset:3072 lds
    s_add_u32 s54, s54, 262144
    s_add_u32 s55, s55, 221184
    s_add_u32 s56, s56, 49152
    s_cmp_eq_u32 s56, s59
    s_cselect_b32 s56, s58, s56
Lni_119:
    s_cmp_eq_u32 s57, s62
    s_cbranch_scc1 Lact_120
Lret_121:
    s_add_u32 s57, s57, 1
    s_cmp_lt_u32 s57, 10
    s_cbranch_scc1 Lp4l_116
    s_cmp_lt_u32 s31, 2
    s_cbranch_scc1 Lsd_132
    s_cmp_eq_u32 s64, 1
    s_cbranch_scc1 Lcsok_133
    v_mov_b32 v5, 32
    s_mov_b32 s52, 40000
Lpoll_134:
    buffer_load_dword v1, v3, s[16:19], 0 offen sc1
    s_waitcnt vmcnt(0)
    v_cmp_le_u32 vcc, v5, v1
    s_cmp_eq_u64 vcc, -1
    s_cbranch_scc1 Lpolld_135
    s_sleep 1
    s_sub_u32 s52, s52, 1
    s_cmp_lg_u32 s52, 0
    s_cbranch_scc1 Lpoll_134
Lpolld_135:
    s_add_u32 s53, s63, 0
    buffer_load_dwordx2 v[24:25], v2, s[16:19], s53 offen sc1
    s_add_u32 s53, s63, 16384
    buffer_load_dwordx2 v[26:27], v2, s[16:19], s53 offen sc1
    s_add_u32 s53, s63, 32768
    buffer_load_dwordx2 v[28:29], v2, s[16:19], s53 offen sc1
    s_add_u32 s53, s63, 49152
    buffer_load_dwordx2 v[30:31], v2, s[16:19], s53 offen sc1
Lcsok_133:
    s_waitcnt vmcnt(0)
    v_add_f32 v24, v24, v26
    v_add_f32 v25, v25, v27
    v_add_f32 v28, v28, v30
    v_add_f32 v29, v29, v31
    v_add_f32 v24, v24, v28
    v_add_f32 v25, v25, v29
    s_sub_u32 s52, s31, 2
    s_lshl_b32 s52, s52, 9
    s_add_u32 s52, s52, 148480
    v_add_u32 v2, s52, v2
    ds_write_b64 v2, v[24:25]
    s_waitcnt lgkmcnt(0)
Lsd_132:
    s_barrier
    s_cmp_lg_u32 s30, 5
    s_cbranch_scc1 Lnorp_136
    v_mov_b32 v2, 16640
    v_mov_b32 v3, 32
    s_mov_b32 s52, 40000
Lpoll_137:
    buffer_load_dword v1, v2, s[16:19], 0 offen sc1
    s_waitcnt vmcnt(0)
    v_cmp_le_u32 vcc, v3, v1
    s_cmp_eq_u64 vcc, -1
    s_cbranch_scc1 Lpolld_138
    s_sleep 1
    s_sub_u32 s52, s52, 1
    s_cmp_lg_u32 s52, 0
    s_cbranch_scc1 Lpoll_137
Lpolld_138:
Lnorp_136:
    s_barrier
    s_cmp_lg_u32 s30, 4
    s_cbranch_scc1 Lnosig_139
    s_lshl_b32 s52, s28, 6
    s_add_u32 s52, s52, s29
    s_add_u32 s52, s52, 48
    s_mul_i32 s52, s52, 128
    s_add_u32 s52, s52, 131072
    v_mov_b32 v1, 1
    s_mov_b64 exec, 1
    buffer_store_dword v1, off, s[16:19], s52 sc1
    s_mov_b64 exec, -1
Lnosig_139:
    s_branch Lp5_105
Lp4aux_103:
    s_mov_b32 s8, s44
    s_and_b32 s9, s45, 0xffff
    s_mov_b32 s10, 2211840
    s_mov_b32 s11, 0x20000
    s_lshl_b32 s52, s28, 1
    s_add_u32 s52, s52, s29
    s_sub_u32 s52, s52, 14
    s_lshr_b32 s54, s52, 2
    s_and_b32 s55, s52, 3
    s_mul_i32 s55, s55, 432
    s_mul_i32 s56, s54, 276480
    s_mul_i32 s59, s55, 160
    s_add_u32 s56, s56, s59
    s_add_u32 s56, s56, 2097152
    s_lshl_b32 s59, s28, 1
    s_add_u32 s59, s59, s29
    s_sub_u32 s59, s59, 14
    s_lshl_b32 s60, s30, 5
    s_add_u32 s60, s60, s59
    s_cmp_lt_u32 s60, 216
    s_cbranch_scc0 Lnocs_140
    s_lshr_b32 s61, s60, 2
    s_and_b32 s62, s60, 3
    s_cmp_ge_u32 s61, 27
    s_cselect_b32 s63, 1, 0
    s_cselect_b32 s64, s42, s40
    s_cselect_b32 s65, s43, s41
    s_mul_i32 s66, s63, 27
    s_sub_u32 s61, s61, s66
    s_mov_b32 s12, s64
    s_and_b32 s13, s65, 0xffff
    s_mov_b32 s14, 2211840
    s_mov_b32 s15, 0x20000
    v_lshrrev_b32 v2, 3, v0
    v_mul_u32_u24 v2, 3456, v2
    v_and_b32 v3, 7, v0
    v_lshl_add_u32 v2, v3, 4, v2
    s_mul_i32 s66, s62, 552960
    s_lshl_b32 s67, s61, 7
    s_add_u32 s66, s66, s67
    buffer_load_dwordx4 v[64:67], v2, s[12:15], s66 offen
    s_add_u32 s66, s66, 27648
    buffer_load_dwordx4 v[68:71], v2, s[12:15], s66 offen
    s_add_u32 s66, s66, 27648
    buffer_load_dwordx4 v[72:75], v2, s[12:15], s66 offen
    s_add_u32 s66, s66, 27648
    buffer_load_dwordx4 v[76:79], v2, s[12:15], s66 offen
    s_add_u32 s66, s66, 27648
    buffer_load_dwordx4 v[80:83], v2, s[12:15], s66 offen
    s_add_u32 s66, s66, 27648
    buffer_load_dwordx4 v[84:87], v2, s[12:15], s66 offen
    s_add_u32 s66, s66, 27648
    buffer_load_dwordx4 v[88:91], v2, s[12:15], s66 offen
    s_add_u32 s66, s66, 27648
    buffer_load_dwordx4 v[92:95], v2, s[12:15], s66 offen
    s_add_u32 s66, s66, 27648
    buffer_load_dwordx4 v[96:99], v2, s[12:15], s66 offen
    s_add_u32 s66, s66, 27648
    buffer_load_dwordx4 v[100:103], v2, s[12:15], s66 offen
    s_add_u32 s66, s66, 27648
    buffer_load_dwordx4 v[104:107], v2, s[12:15], s66 offen
    s_add_u32 s66, s66, 27648
    buffer_load_dwordx4 v[108:111], v2, s[12:15], s66 offen
    s_add_u32 s66, s66, 27648
    buffer_load_dwordx4 v[112:115], v2, s[12:15], s66 offen
    s_add_u32 s66, s66, 27648
    buffer_load_dwordx4 v[116:119], v2, s[12:15], s66 offen
    s_add_u32 s66, s66, 27648
    buffer_load_dwordx4 v[120:123], v2, s[12:15], s66 offen
    s_add_u32 s66, s66, 27648
    buffer_load_dwordx4 v[124:127], v2, s[12:15], s66 offen
    s_add_u32 s66, s66, 27648
    buffer_load_dwordx4 v[128:131], v2, s[12:15], s66 offen
    s_add_u32 s66, s66, 27648
    buffer_load_dwordx4 v[132:135], v2, s[12:15], s66 offen
    s_add_u32 s66, s66, 27648
    buffer_load_dwordx4 v[136:139], v2, s[12:15], s66 offen
    s_add_u32 s66, s66, 27648
    buffer_load_dwordx4 v[140:143], v2, s[12:15], s66 offen
    v_mov_b32 v56, 0
    v_mov_b32 v57, 0
    v_mov_b32 v58, 0
    v_mov_b32 v59, 0
    v_mov_b32 v60, 0
    v_mov_b32 v61, 0
    v_mov_b32 v62, 0
    v_mov_b32 v63, 0
    s_waitcnt vmcnt(16)
    v_lshlrev_b32 v52, 16, v64
    v_and_b32 v53, 0xffff0000, v64
    v_pk_add_f32 v[56:57], v[56:57], v[52:53]
    v_lshlrev_b32 v54, 16, v65
    v_and_b32 v55, 0xffff0000, v65
    v_pk_add_f32 v[58:59], v[58:59], v[54:55]
    v_lshlrev_b32 v52, 16, v66
    v_and_b32 v53, 0xffff0000, v66
    v_pk_add_f32 v[60:61], v[60:61], v[52:53]
    v_lshlrev_b32 v54, 16, v67
    v_and_b32 v55, 0xffff0000, v67
    v_pk_add_f32 v[62:63], v[62:63], v[54:55]
    v_lshlrev_b32 v52, 16, v68
    v_and_b32 v53, 0xffff0000, v68
    v_pk_add_f32 v[56:57], v[56:57], v[52:53]
    v_lshlrev_b32 v54, 16, v69
    v_and_b32 v55, 0xffff0000, v69
    v_pk_add_f32 v[58:59], v[58:59], v[54:55]
    v_lshlrev_b32 v52, 16, v70
    v_and_b32 v53, 0xffff0000, v70
    v_pk_add_f32 v[60:61], v[60:61], v[52:53]
    v_lshlrev_b32 v54, 16, v71
    v_and_b32 v55, 0xffff0000, v71
    v_pk_add_f32 v[62:63], v[62:63], v[54:55]
    v_lshlrev_b32 v52, 16, v72
    v_and_b32 v53, 0xffff0000, v72
    v_pk_add_f32 v[56:57], v[56:57], v[52:53]
    v_lshlrev_b32 v54, 16, v73
    v_and_b32 v55, 0xffff0000, v73
    v_pk_add_f32 v[58:59], v[58:59], v[54:55]
    v_lshlrev_b32 v52, 16, v74
    v_and_b32 v53, 0xffff0000, v74
    v_pk_add_f32 v[60:61], v[60:61], v[52:53]
    v_lshlrev_b32 v54, 16, v75
    v_and_b32 v55, 0xffff0000, v75
    v_pk_add_f32 v[62:63], v[62:63], v[54:55]
    v_lshlrev_b32 v52, 16, v76
    v_and_b32 v53, 0xffff0000, v76
    v_pk_add_f32 v[56:57], v[56:57], v[52:53]
    v_lshlrev_b32 v54, 16, v77
    v_and_b32 v55, 0xffff0000, v77
    v_pk_add_f32 v[58:59], v[58:59], v[54:55]
    v_lshlrev_b32 v52, 16, v78
    v_and_b32 v53, 0xffff0000, v78
    v_pk_add_f32 v[60:61], v[60:61], v[52:53]
    v_lshlrev_b32 v54, 16, v79
    v_and_b32 v55, 0xffff0000, v79
    v_pk_add_f32 v[62:63], v[62:63], v[54:55]
    s_waitcnt vmcnt(12)
    v_lshlrev_b32 v52, 16, v80
    v_and_b32 v53, 0xffff0000, v80
    v_pk_add_f32 v[56:57], v[56:57], v[52:53]
    v_lshlrev_b32 v54, 16, v81
    v_and_b32 v55, 0xffff0000, v81
    v_pk_add_f32 v[58:59], v[58:59], v[54:55]
    v_lshlrev_b32 v52, 16, v82
    v_and_b32 v53, 0xffff0000, v82
    v_pk_add_f32 v[60:61], v[60:61], v[52:53]
    v_lshlrev_b32 v54, 16, v83
    v_and_b32 v55, 0xffff0000, v83
    v_pk_add_f32 v[62:63], v[62:63], v[54:55]
    v_lshlrev_b32 v52, 16, v84
    v_and_b32 v53, 0xffff0000, v84
    v_pk_add_f32 v[56:57], v[56:57], v[52:53]
    v_lshlrev_b32 v54, 16, v85
    v_and_b32 v55, 0xffff0000, v85
    v_pk_add_f32 v[58:59], v[58:59], v[54:55]
    v_lshlrev_b32 v52, 16, v86
    v_and_b32 v53, 0xffff0000, v86
    v_pk_add_f32 v[60:61], v[60:61], v[52:53]
    v_lshlrev_b32 v54, 16, v87
    v_and_b32 v55, 0xffff0000, v87
    v_pk_add_f32 v[62:63], v[62:63], v[54:55]
    v_lshlrev_b32 v52, 16, v88
    v_and_b32 v53, 0xffff0000, v88
    v_pk_add_f32 v[56:57], v[56:57], v[52:53]
    v_lshlrev_b32 v54, 16, v89
    v_and_b32 v55, 0xffff0000, v89
    v_pk_add_f32 v[58:59], v[58:59], v[54:55]
    v_lshlrev_b32 v52, 16, v90
    v_and_b32 v53, 0xffff0000, v90
    v_pk_add_f32 v[60:61], v[60:61], v[52:53]
    v_lshlrev_b32 v54, 16, v91
    v_and_b32 v55, 0xffff0000, v91
    v_pk_add_f32 v[62:63], v[62:63], v[54:55]
    v_lshlrev_b32 v52, 16, v92
    v_and_b32 v53, 0xffff0000, v92
    v_pk_add_f32 v[56:57], v[56:57], v[52:53]
    v_lshlrev_b32 v54, 16, v93
    v_and_b32 v55, 0xffff0000, v93
    v_pk_add_f32 v[58:59], v[58:59], v[54:55]
    v_lshlrev_b32 v52, 16, v94
    v_and_b32 v53, 0xffff0000, v94
    v_pk_add_f32 v[60:61], v[60:61], v[52:53]
    v_lshlrev_b32 v54, 16, v95
    v_and_b32 v55, 0xffff0000, v95
    v_pk_add_f32 v[62:63], v[62:63], v[54:55]
    s_waitcnt vmcnt(8)
    v_lshlrev_b32 v52, 16, v96
    v_and_b32 v53, 0xffff0000, v96
    v_pk_add_f32 v[56:57], v[56:57], v[52:53]
    v_lshlrev_b32 v54, 16, v97
    v_and_b32 v55, 0xffff0000, v97
    v_pk_add_f32 v[58:59], v[58:59], v[54:55]
    v_lshlrev_b32 v52, 16, v98
    v_and_b32 v53, 0xffff0000, v98
    v_pk_add_f32 v[60:61], v[60:61], v[52:53]
    v_lshlrev_b32 v54, 16, v99
    v_and_b32 v55, 0xffff0000, v99
    v_pk_add_f32 v[62:63], v[62:63], v[54:55]
    v_lshlrev_b32 v52, 16, v100
    v_and_b32 v53, 0xffff0000, v100
    v_pk_add_f32 v[56:57], v[56:57], v[52:53]
    v_lshlrev_b32 v54, 16, v101
    v_and_b32 v55, 0xffff0000, v101
    v_pk_add_f32 v[58:59], v[58:59], v[54:55]
    v_lshlrev_b32 v52, 16, v102
    v_and_b32 v53, 0xffff0000, v102
    v_pk_add_f32 v[60:61], v[60:61], v[52:53]
    v_lshlrev_b32 v54, 16, v103
    v_and_b32 v55, 0xffff0000, v103
    v_pk_add_f32 v[62:63], v[62:63], v[54:55]
    v_lshlrev_b32 v52, 16, v104
    v_and_b32 v53, 0xffff0000, v104
    v_pk_add_f32 v[56:57], v[56:57], v[52:53]
    v_lshlrev_b32 v54, 16, v105
    v_and_b32 v55, 0xffff0000, v105
    v_pk_add_f32 v[58:59], v[58:59], v[54:55]
    v_lshlrev_b32 v52, 16, v106
    v_and_b32 v53, 0xffff0000, v106
    v_pk_add_f32 v[60:61], v[60:61], v[52:53]
    v_lshlrev_b32 v54, 16, v107
    v_and_b32 v55, 0xffff0000, v107
    v_pk_add_f32 v[62:63], v[62:63], v[54:55]
    v_lshlrev_b32 v52, 16, v108
    v_and_b32 v53, 0xffff0000, v108
    v_pk_add_f32 v[56:57], v[56:57], v[52:53]
    v_lshlrev_b32 v54, 16, v109
    v_and_b32 v55, 0xffff0000, v109
    v_pk_add_f32 v[58:59], v[58:59], v[54:55]
    v_lshlrev_b32 v52, 16, v110
    v_and_b32 v53, 0xffff0000, v110
    v_pk_add_f32 v[60:61], v[60:61], v[52:53]
    v_lshlrev_b32 v54, 16, v111
    v_and_b32 v55, 0xffff0000, v111
    v_pk_add_f32 v[62:63], v[62:63], v[54:55]
    s_waitcnt vmcnt(4)
    v_lshlrev_b32 v52, 16, v112
    v_and_b32 v53, 0xffff0000, v112
    v_pk_add_f32 v[56:57], v[56:57], v[52:53]
    v_lshlrev_b32 v54, 16, v113
    v_and_b32 v55, 0xffff0000, v113
    v_pk_add_f32 v[58:59], v[58:59], v[54:55]
    v_lshlrev_b32 v52, 16, v114
    v_and_b32 v53, 0xffff0000, v114
    v_pk_add_f32 v[60:61], v[60:61], v[52:53]
    v_lshlrev_b32 v54, 16, v115
    v_and_b32 v55, 0xffff0000, v115
    v_pk_add_f32 v[62:63], v[62:63], v[54:55]
    v_lshlrev_b32 v52, 16, v116
    v_and_b32 v53, 0xffff0000, v116
    v_pk_add_f32 v[56:57], v[56:57], v[52:53]
    v_lshlrev_b32 v54, 16, v117
    v_and_b32 v55, 0xffff0000, v117
    v_pk_add_f32 v[58:59], v[58:59], v[54:55]
    v_lshlrev_b32 v52, 16, v118
    v_and_b32 v53, 0xffff0000, v118
    v_pk_add_f32 v[60:61], v[60:61], v[52:53]
    v_lshlrev_b32 v54, 16, v119
    v_and_b32 v55, 0xffff0000, v119
    v_pk_add_f32 v[62:63], v[62:63], v[54:55]
    v_lshlrev_b32 v52, 16, v120
    v_and_b32 v53, 0xffff0000, v120
    v_pk_add_f32 v[56:57], v[56:57], v[52:53]
    v_lshlrev_b32 v54, 16, v121
    v_and_b32 v55, 0xffff0000, v121
    v_pk_add_f32 v[58:59], v[58:59], v[54:55]
    v_lshlrev_b32 v52, 16, v122
    v_and_b32 v53, 0xffff0000, v122
    v_pk_add_f32 v[60:61], v[60:61], v[52:53]
    v_lshlrev_b32 v54, 16, v123
    v_and_b32 v55, 0xffff0000, v123
    v_pk_add_f32 v[62:63], v[62:63], v[54:55]
    v_lshlrev_b32 v52, 16, v124
    v_and_b32 v53, 0xffff0000, v124
    v_pk_add_f32 v[56:57], v[56:57], v[52:53]
    v_lshlrev_b32 v54, 16, v125
    v_and_b32 v55, 0xffff0000, v125
    v_pk_add_f32 v[58:59], v[58:59], v[54:55]
    v_lshlrev_b32 v52, 16, v126
    v_and_b32 v53, 0xffff0000, v126
    v_pk_add_f32 v[60:61], v[60:61], v[52:53]
    v_lshlrev_b32 v54, 16, v127
    v_and_b32 v55, 0xffff0000, v127
    v_pk_add_f32 v[62:63], v[62:63], v[54:55]
    s_waitcnt vmcnt(0)
    v_lshlrev_b32 v52, 16, v128
    v_and_b32 v53, 0xffff0000, v128
    v_pk_add_f32 v[56:57], v[56:57], v[52:53]
    v_lshlrev_b32 v54, 16, v129
    v_and_b32 v55, 0xffff0000, v129
    v_pk_add_f32 v[58:59], v[58:59], v[54:55]
    v_lshlrev_b32 v52, 16, v130
    v_and_b32 v53, 0xffff0000, v130
    v_pk_add_f32 v[60:61], v[60:61], v[52:53]
    v_lshlrev_b32 v54, 16, v131
    v_and_b32 v55, 0xffff0000, v131
    v_pk_add_f32 v[62:63], v[62:63], v[54:55]
    v_lshlrev_b32 v52, 16, v132
    v_and_b32 v53, 0xffff0000, v132
    v_pk_add_f32 v[56:57], v[56:57], v[52:53]
    v_lshlrev_b32 v54, 16, v133
    v_and_b32 v55, 0xffff0000, v133
    v_pk_add_f32 v[58:59], v[58:59], v[54:55]
    v_lshlrev_b32 v52, 16, v134
    v_and_b32 v53, 0xffff0000, v134
    v_pk_add_f32 v[60:61], v[60:61], v[52:53]
    v_lshlrev_b32 v54, 16, v135
    v_and_b32 v55, 0xffff0000, v135
    v_pk_add_f32 v[62:63], v[62:63], v[54:55]
    v_lshlrev_b32 v52, 16, v136
    v_and_b32 v53, 0xffff0000, v136
    v_pk_add_f32 v[56:57], v[56:57], v[52:53]
    v_lshlrev_b32 v54, 16, v137
    v_and_b32 v55, 0xffff0000, v137
    v_pk_add_f32 v[58:59], v[58:59], v[54:55]
    v_lshlrev_b32 v52, 16, v138
    v_and_b32 v53, 0xffff0000, v138
    v_pk_add_f32 v[60:61], v[60:61], v[52:53]
    v_lshlrev_b32 v54, 16, v139
    v_and_b32 v55, 0xffff0000, v139
    v_pk_add_f32 v[62:63], v[62:63], v[54:55]
    v_lshlrev_b32 v52, 16, v140
    v_and_b32 v53, 0xffff0000, v140
    v_pk_add_f32 v[56:57], v[56:57], v[52:53]
    v_lshlrev_b32 v54, 16, v141
    v_and_b32 v55, 0xffff0000, v141
    v_pk_add_f32 v[58:59], v[58:59], v[54:55]
    v_lshlrev_b32 v52, 16, v142
    v_and_b32 v53, 0xffff0000, v142
    v_pk_add_f32 v[60:61], v[60:61], v[52:53]
    v_lshlrev_b32 v54, 16, v143
    v_and_b32 v55, 0xffff0000, v143
    v_pk_add_f32 v[62:63], v[62:63], v[54:55]
    v_add_f32_dpp v56, v56, v56 row_ror:8 row_mask:0xf bank_mask:0xf
    v_add_f32_dpp v57, v57, v57 row_ror:8 row_mask:0xf bank_mask:0xf
    v_add_f32_dpp v58, v58, v58 row_ror:8 row_mask:0xf bank_mask:0xf
    v_add_f32_dpp v59, v59, v59 row_ror:8 row_mask:0xf bank_mask:0xf
    v_add_f32_dpp v60, v60, v60 row_ror:8 row_mask:0xf bank_mask:0xf
    v_add_f32_dpp v61, v61, v61 row_ror:8 row_mask:0xf bank_mask:0xf
    v_add_f32_dpp v62, v62, v62 row_ror:8 row_mask:0xf bank_mask:0xf
    v_add_f32_dpp v63, v63, v63 row_ror:8 row_mask:0xf bank_mask:0xf
    v_mov_b32 v64, v56
    v_mov_b32 v65, v57
    v_mov_b32 v66, v58
    v_mov_b32 v67, v59
    v_mov_b32 v68, v60
    v_mov_b32 v69, v61
    v_mov_b32 v70, v62
    v_mov_b32 v71, v63
    v_permlane16_swap_b32 v56, v64
    v_permlane16_swap_b32 v57, v65
    v_permlane16_swap_b32 v58, v66
    v_permlane16_swap_b32 v59, v67
    v_permlane16_swap_b32 v60, v68
    v_permlane16_swap_b32 v61, v69
    v_permlane16_swap_b32 v62, v70
    v_permlane16_swap_b32 v63, v71
    v_add_f32 v56, v56, v64
    v_add_f32 v57, v57, v65
    v_add_f32 v58, v58, v66
    v_add_f32 v59, v59, v67
    v_add_f32 v60, v60, v68
    v_add_f32 v61, v61, v69
    v_add_f32 v62, v62, v70
    v_add_f32 v63, v63, v71
    v_mov_b32 v64, v56
    v_mov_b32 v65, v57
    v_mov_b32 v66, v58
    v_mov_b32 v67, v59
    v_mov_b32 v68, v60
    v_mov_b32 v69, v61
    v_mov_b32 v70, v62
    v_mov_b32 v71, v63
    v_permlane32_swap_b32 v56, v64
    v_permlane32_swap_b32 v57, v65
    v_permlane32_swap_b32 v58, v66
    v_permlane32_swap_b32 v59, v67
    v_permlane32_swap_b32 v60, v68
    v_permlane32_swap_b32 v61, v69
    v_permlane32_swap_b32 v62, v70
    v_permlane32_swap_b32 v63, v71
    v_add_f32 v56, v56, v64
    v_add_f32 v57, v57, v65
    v_add_f32 v58, v58, v66
    v_add_f32 v59, v59, v67
    v_add_f32 v60, v60, v68
    v_add_f32 v61, v61, v69
    v_add_f32 v62, v62, v70
    v_add_f32 v63, v63, v71
    s_lshl_b32 s66, s62, 14
    s_lshl_b32 s67, s63, 13
    s_add_u32 s66, s66, s67
    s_lshl_b32 s67, s61, 8
    s_add_u32 s66, s66, s67
    s_add_u32 s66, s66, 65536
    v_lshlrev_b32 v2, 5, v0
    s_mov_b64 exec, 0xff
    buffer_store_dwordx4 v[56:59], v2, s[16:19], s66 offen sc1
    buffer_store_dwordx4 v[60:63], v2, s[16:19], s66 offen offset:16 sc1
    s_mov_b64 exec, -1
    s_waitcnt vmcnt(0)
Lnocs_140:
    s_barrier
    s_cmp_lg_u32 s30, 4
    s_cbranch_scc1 Lnosig_141
    s_mov_b32 s52, 16896
    v_mov_b32 v1, 1
    s_mov_b64 exec, 1
    buffer_atomic_add v1, off, s[16:19], s52 sc1
    s_mov_b64 exec, -1
Lnosig_141:
    s_lshl_b32 s52, s30, 6
    v_add_u32 v1, s52, v0
    s_mul_i32 s53, s54, 160
    s_mov_b32 s57, 52429
    s_mov_b32 s58, 4320
    v_add_u32 v2, 0, v1
    v_mul_lo_u32 v3, v2, s57
    v_lshrrev_b32 v3, 19, v3
    v_mul_u32_u24 v4, 10, v3
    v_sub_u32 v4, v2, v4
    v_add_u32 v3, s55, v3
    v_and_b32 v5, 0xfffffff3, v3
    v_and_b32 v6, 4, v3
    v_lshl_or_b32 v5, v6, 1, v5
    v_and_b32 v6, 8, v3
    v_lshrrev_b32 v6, 1, v6
    v_or_b32 v5, v5, v6
    v_mul_u32_u24 v5, 1280, v5
    v_lshl_add_u32 v5, v4, 4, v5
    v_add_u32 v5, s53, v5
    v_lshlrev_b32 v10, 4, v2
    buffer_load_dwordx4 v[24:27], v5, s[8:11], 0 offen
    v_add_u32 v2, 512, v1
    v_mul_lo_u32 v3, v2, s57
    v_lshrrev_b32 v3, 19, v3
    v_mul_u32_u24 v4, 10, v3
    v_sub_u32 v4, v2, v4
    v_add_u32 v3, s55, v3
    v_and_b32 v5, 0xfffffff3, v3
    v_and_b32 v6, 4, v3
    v_lshl_or_b32 v5, v6, 1, v5
    v_and_b32 v6, 8, v3
    v_lshrrev_b32 v6, 1, v6
    v_or_b32 v5, v5, v6
    v_mul_u32_u24 v5, 1280, v5
    v_lshl_add_u32 v5, v4, 4, v5
    v_add_u32 v5, s53, v5
    v_lshlrev_b32 v11, 4, v2
    buffer_load_dwordx4 v[28:31], v5, s[8:11], 0 offen
    v_add_u32 v2, 1024, v1
    v_mul_lo_u32 v3, v2, s57
    v_lshrrev_b32 v3, 19, v3
    v_mul_u32_u24 v4, 10, v3
    v_sub_u32 v4, v2, v4
    v_add_u32 v3, s55, v3
    v_and_b32 v5, 0xfffffff3, v3
    v_and_b32 v6, 4, v3
    v_lshl_or_b32 v5, v6, 1, v5
    v_and_b32 v6, 8, v3
    v_lshrrev_b32 v6, 1, v6
    v_or_b32 v5, v5, v6
    v_mul_u32_u24 v5, 1280, v5
    v_lshl_add_u32 v5, v4, 4, v5
    v_add_u32 v5, s53, v5
    v_lshlrev_b32 v12, 4, v2
    buffer_load_dwordx4 v[32:35], v5, s[8:11], 0 offen
    v_add_u32 v2, 1536, v1
    v_mul_lo_u32 v3, v2, s57
    v_lshrrev_b32 v3, 19, v3
    v_mul_u32_u24 v4, 10, v3
    v_sub_u32 v4, v2, v4
    v_add_u32 v3, s55, v3
    v_and_b32 v5, 0xfffffff3, v3
    v_and_b32 v6, 4, v3
    v_lshl_or_b32 v5, v6, 1, v5
    v_and_b32 v6, 8, v3
    v_lshrrev_b32 v6, 1, v6
    v_or_b32 v5, v5, v6
    v_mul_u32_u24 v5, 1280, v5
    v_lshl_add_u32 v5, v4, 4, v5
    v_add_u32 v5, s53, v5
    v_lshlrev_b32 v13, 4, v2
    buffer_load_dwordx4 v[36:39], v5, s[8:11], 0 offen
    v_add_u32 v2, 2048, v1
    v_mul_lo_u32 v3, v2, s57
    v_lshrrev_b32 v3, 19, v3
    v_mul_u32_u24 v4, 10, v3
    v_sub_u32 v4, v2, v4
    v_add_u32 v3, s55, v3
    v_and_b32 v5, 0xfffffff3, v3
    v_and_b32 v6, 4, v3
    v_lshl_or_b32 v5, v6, 1, v5
    v_and_b32 v6, 8, v3
    v_lshrrev_b32 v6, 1, v6
    v_or_b32 v5, v5, v6
    v_mul_u32_u24 v5, 1280, v5
    v_lshl_add_u32 v5, v4, 4, v5
    v_add_u32 v5, s53, v5
    v_lshlrev_b32 v14, 4, v2
    buffer_load_dwordx4 v[40:43], v5, s[8:11], 0 offen
    v_add_u32 v2, 2560, v1
    v_mul_lo_u32 v3, v2, s57
    v_lshrrev_b32 v3, 19, v3
    v_mul_u32_u24 v4, 10, v3
    v_sub_u32 v4, v2, v4
    v_add_u32 v3, s55, v3
    v_and_b32 v5, 0xfffffff3, v3
    v_and_b32 v6, 4, v3
    v_lshl_or_b32 v5, v6, 1, v5
    v_and_b32 v6, 8, v3
    v_lshrrev_b32 v6, 1, v6
    v_or_b32 v5, v5, v6
    v_mul_u32_u24 v5, 1280, v5
    v_lshl_add_u32 v5, v4, 4, v5
    v_add_u32 v5, s53, v5
    v_lshlrev_b32 v15, 4, v2
    buffer_load_dwordx4 v[44:47], v5, s[8:11], 0 offen
    v_add_u32 v2, 3072, v1
    v_mul_lo_u32 v3, v2, s57
    v_lshrrev_b32 v3, 19, v3
    v_mul_u32_u24 v4, 10, v3
    v_sub_u32 v4, v2, v4
    v_add_u32 v3, s55, v3
    v_and_b32 v5, 0xfffffff3, v3
    v_and_b32 v6, 4, v3
    v_lshl_or_b32 v5, v6, 1, v5
    v_and_b32 v6, 8, v3
    v_lshrrev_b32 v6, 1, v6
    v_or_b32 v5, v5, v6
    v_mul_u32_u24 v5, 1280, v5
    v_lshl_add_u32 v5, v4, 4, v5
    v_add_u32 v5, s53, v5
    v_lshlrev_b32 v16, 4, v2
    buffer_load_dwordx4 v[48:51], v5, s[8:11], 0 offen
    v_add_u32 v2, 3584, v1
    v_mul_lo_u32 v3, v2, s57
    v_lshrrev_b32 v3, 19, v3
    v_mul_u32_u24 v4, 10, v3
    v_sub_u32 v4, v2, v4
    v_add_u32 v3, s55, v3
    v_and_b32 v5, 0xfffffff3, v3
    v_and_b32 v6, 4, v3
    v_lshl_or_b32 v5, v6, 1, v5
    v_and_b32 v6, 8, v3
    v_lshrrev_b32 v6, 1, v6
    v_or_b32 v5, v5, v6
    v_mul_u32_u24 v5, 1280, v5
    v_lshl_add_u32 v5, v4, 4, v5
    v_add_u32 v5, s53, v5
    v_lshlrev_b32 v17, 4, v2
    buffer_load_dwordx4 v[52:55], v5, s[8:11], 0 offen
    v_add_u32 v2, 4096, v1
    v_mul_lo_u32 v3, v2, s57
    v_lshrrev_b32 v3, 19, v3
    v_mul_u32_u24 v4, 10, v3
    v_sub_u32 v4, v2, v4
    v_add_u32 v3, s55, v3
    v_and_b32 v5, 0xfffffff3, v3
    v_and_b32 v6, 4, v3
    v_lshl_or_b32 v5, v6, 1, v5
    v_and_b32 v6, 8, v3
    v_lshrrev_b32 v6, 1, v6
    v_or_b32 v5, v5, v6
    v_mul_u32_u24 v5, 1280, v5
    v_lshl_add_u32 v5, v4, 4, v5
    v_add_u32 v5, s53, v5
    v_lshlrev_b32 v18, 4, v2
    v_cmp_gt_u32 vcc, s58, v2
    s_and_saveexec_b64 s[68:69], vcc
    buffer_load_dwordx4 v[56:59], v5, s[8:11], 0 offen
    s_mov_b64 exec, -1
    s_waitcnt vmcnt(0)
    buffer_store_dwordx4 v[24:27], v10, s[16:19], s56 offen sc1
    buffer_store_dwordx4 v[28:31], v11, s[16:19], s56 offen sc1
    buffer_store_dwordx4 v[32:35], v12, s[16:19], s56 offen sc1
    buffer_store_dwordx4 v[36:39], v13, s[16:19], s56 offen sc1
    buffer_store_dwordx4 v[40:43], v14, s[16:19], s56 offen sc1
    buffer_store_dwordx4 v[44:47], v15, s[16:19], s56 offen sc1
    buffer_store_dwordx4 v[48:51], v16, s[16:19], s56 offen sc1
    buffer_store_dwordx4 v[52:55], v17, s[16:19], s56 offen sc1
    v_cmp_gt_u32 vcc, s58, v2
    s_and_saveexec_b64 s[68:69], vcc
    buffer_store_dwordx4 v[56:59], v18, s[16:19], s56 offen sc1
    s_mov_b64 exec, -1
    s_waitcnt vmcnt(0)
    s_barrier
    s_cmp_lg_u32 s30, 4
    s_cbranch_scc1 Lnosig_142
    s_mov_b32 s52, 16640
    v_mov_b32 v1, 1
    s_mov_b64 exec, 1
    buffer_atomic_add v1, off, s[16:19], s52 sc1
    s_mov_b64 exec, -1
Lnosig_142:
    s_cmp_lg_u32 s30, 5
    s_cbranch_scc1 Lnorp_143
    v_mov_b32 v2, 16640
    v_mov_b32 v3, 32
    s_mov_b32 s52, 40000
Lpoll_144:
    buffer_load_dword v1, v2, s[16:19], 0 offen sc1
    s_waitcnt vmcnt(0)
    v_cmp_le_u32 vcc, v3, v1
    s_cmp_eq_u64 vcc, -1
    s_cbranch_scc1 Lpolld_145
    s_sleep 1
    s_sub_u32 s52, s52, 1
    s_cmp_lg_u32 s52, 0
    s_cbranch_scc1 Lpoll_144
Lpolld_145:
Lnorp_143:
    s_barrier
Lp5_105:
    s_cmp_ge_u32 s30, 4
    s_cbranch_scc1 Lp5ld_146
    s_and_b32 s54, s30, 1
    s_lshr_b32 s55, s30, 1
    v_lshrrev_b32 v1, 4, v0
    v_and_b32 v2, 15, v0
    s_lshl_b32 s52, s54, 5
    v_add_u32 v3, s52, v2
    v_lshlrev_b32 v4, 4, v3
    v_lshl_add_u32 v42, v1, 10, v4
    v_lshrrev_b32 v5, 1, v1
    v_lshlrev_b32 v5, 4, v5
    v_and_b32 v6, 1, v1
    v_lshl_add_u32 v5, v6, 2, v5
    v_bfe_u32 v6, v0, 2, 2
    v_add_u32 v5, v5, v6
    v_mul_u32_u24 v5, 160, v5
    v_and_b32 v6, 3, v0
    v_lshl_add_u32 v5, v6, 3, v5
    s_lshl_b32 s52, s55, 6
    s_add_u32 s52, s52, 8192
    v_add_u32 v43, s52, v5
    s_lshl_b32 s52, s28, 7
    s_and_b32 s53, s29, 1
    s_lshl_b32 s53, s53, 6
    s_add_u32 s58, s52, s53
    v_add_u32 v44, s58, v3
    s_lshr_b32 s52, s29, 1
    s_mul_i32 s59, s52, 80
    s_lshl_b32 s53, s55, 5
    s_add_u32 s59, s59, s53
    v_and_b32 v2, 15, v0
    v_bfe_u32 v3, v0, 4, 1
    v_lshl_add_u32 v2, v3, 4, v2
    s_lshl_b32 s53, s54, 5
    s_add_u32 s53, s53, s58
    v_add_u32 v2, s53, v2
    v_lshrrev_b32 v3, 5, v0
    v_mul_u32_u24 v2, 1280, v2
    v_lshl_add_u32 v46, v3, 4, v2
    s_lshl_b32 s60, s59, 1
    s_cmp_lg_u32 s30, 0
    s_cbranch_scc1 Lnopoll_148
    v_and_b32 v3, 15, v0
    s_lshl_b32 s52, s28, 6
    s_add_u32 s52, s52, 48
    v_add_u32 v2, s52, v3
    v_mul_u32_u24 v2, 128, v2
    v_add_u32 v2, 131072, v2
    v_cmp_gt_u32 vcc, 14, v3
    s_nop 1
    v_cndmask_b32 v3, 0, 1, vcc
    s_mov_b32 s52, 40000
Lpoll_149:
    buffer_load_dword v1, v2, s[16:19], 0 offen sc1
    s_waitcnt vmcnt(0)
    v_cmp_le_u32 vcc, v3, v1
    s_cmp_eq_u64 vcc, -1
    s_cbranch_scc1 Lpolld_150
    s_sleep 1
    s_sub_u32 s52, s52, 1
    s_cmp_lg_u32 s52, 0
    s_cbranch_scc1 Lpoll_149
Lpolld_150:
Lnopoll_148:
    s_barrier
    v_lshrrev_b32 v1, 4, v0
    v_lshrrev_b32 v5, 1, v1
    v_lshlrev_b32 v5, 15, v5
    v_lshl_add_u32 v5, v44, 4, v5
    v_and_b32 v6, 1, v1
    v_lshl_add_u32 v45, v6, 3, v5
    s_lshl_b32 s52, s59, 12
    s_add_u32 s52, s52, 16777216
    s_add_u32 s53, s52, 0
    buffer_load_dwordx2 v[88:89], v45, s[16:19], s53 offen offset:0 sc1
    s_add_u32 s53, s52, 0
    buffer_load_dwordx2 v[90:91], v45, s[16:19], s53 offen offset:256 sc1
    s_add_u32 s53, s52, 65536
    buffer_load_dwordx2 v[92:93], v45, s[16:19], s53 offen offset:0 sc1
    s_add_u32 s53, s52, 65536
    buffer_load_dwordx2 v[94:95], v45, s[16:19], s53 offen offset:256 sc1
    s_add_u32 s53, s52, 131072
    buffer_load_dwordx2 v[96:97], v45, s[16:19], s53 offen offset:0 sc1
    s_add_u32 s53, s52, 131072
    buffer_load_dwordx2 v[98:99], v45, s[16:19], s53 offen offset:256 sc1
    s_mov_b32 s56, 0
    s_mov_b32 s57, 0
    v_mov_b32 v40, v42
    v_mov_b32 v41, v43
    s_barrier
    ds_read_b64_tr_b16 v[112:113], v41 offset:0
    ds_read_b64_tr_b16 v[114:115], v41 offset:1280
    ds_read_b128 v[104:107], v40 offset:0
    ds_read_b64_tr_b16 v[116:117], v41 offset:32
    ds_read_b64_tr_b16 v[118:119], v41 offset:1312
    ds_read_b128 v[108:111], v40 offset:256
    ds_read_b64_tr_b16 v[120:121], v41 offset:64
    ds_read_b64_tr_b16 v[122:123], v41 offset:1344
    ds_read_b64_tr_b16 v[132:133], v41 offset:5120
    ds_read_b64_tr_b16 v[134:135], v41 offset:6400
    ds_read_b128 v[124:127], v40 offset:4096
    ds_read_b64_tr_b16 v[136:137], v41 offset:5152
    ds_read_b64_tr_b16 v[138:139], v41 offset:6432
    ds_read_b128 v[128:131], v40 offset:4352
    ds_read_b64_tr_b16 v[140:141], v41 offset:5184
    ds_read_b64_tr_b16 v[142:143], v41 offset:6464
    s_waitcnt vmcnt(0)
    v_lshlrev_b32 v64, 16, v88
    v_and_b32 v65, 0xffff0000, v88
    v_lshlrev_b32 v66, 16, v89
    v_and_b32 v67, 0xffff0000, v89
    v_lshlrev_b32 v68, 16, v90
    v_and_b32 v69, 0xffff0000, v90
    v_lshlrev_b32 v70, 16, v91
    v_and_b32 v71, 0xffff0000, v91
    v_lshlrev_b32 v72, 16, v92
    v_and_b32 v73, 0xffff0000, v92
    v_lshlrev_b32 v74, 16, v93
    v_and_b32 v75, 0xffff0000, v93
    v_lshlrev_b32 v76, 16, v94
    v_and_b32 v77, 0xffff0000, v94
    v_lshlrev_b32 v78, 16, v95
    v_and_b32 v79, 0xffff0000, v95
    v_lshlrev_b32 v80, 16, v96
    v_and_b32 v81, 0xffff0000, v96
    v_lshlrev_b32 v82, 16, v97
    v_and_b32 v83, 0xffff0000, v97
    v_lshlrev_b32 v84, 16, v98
    v_and_b32 v85, 0xffff0000, v98
    v_lshlrev_b32 v86, 16, v99
    v_and_b32 v87, 0xffff0000, v99
Lg80c_151:
    s_add_u32 s56, s56, 18432
    s_cmp_eq_u32 s56, 147456
    s_cselect_b32 s56, 0, s56
    s_add_u32 s57, s57, 1
    v_add_u32 v40, s56, v42
    v_add_u32 v41, s56, v43
    s_cmp_eq_u32 s57, 27
    s_cbranch_scc1 Lg80x_152
    s_waitcnt lgkmcnt(0)
    s_barrier
    v_mfma_f32_16x16x32_bf16 v[64:67], v[112:115], v[104:107], v[64:67]
    ds_read_b64_tr_b16 v[152:153], v41 offset:0
    ds_read_b64_tr_b16 v[154:155], v41 offset:1280
    v_mfma_f32_16x16x32_bf16 v[68:71], v[112:115], v[108:111], v[68:71]
    ds_read_b128 v[144:147], v40 offset:0
    ds_read_b64_tr_b16 v[156:157], v41 offset:32
    v_mfma_f32_16x16x32_bf16 v[72:75], v[116:119], v[104:107], v[72:75]
    ds_read_b64_tr_b16 v[158:159], v41 offset:1312
    ds_read_b128 v[148:151], v40 offset:256
    v_mfma_f32_16x16x32_bf16 v[76:79], v[116:119], v[108:111], v[76:79]
    ds_read_b64_tr_b16 v[160:161], v41 offset:64
    ds_read_b64_tr_b16 v[162:163], v41 offset:1344
    v_mfma_f32_16x16x32_bf16 v[80:83], v[120:123], v[104:107], v[80:83]
    ds_read_b64_tr_b16 v[172:173], v41 offset:5120
    ds_read_b64_tr_b16 v[174:175], v41 offset:6400
    v_mfma_f32_16x16x32_bf16 v[84:87], v[120:123], v[108:111], v[84:87]
    ds_read_b128 v[164:167], v40 offset:4096
    ds_read_b64_tr_b16 v[176:177], v41 offset:5152
    v_mfma_f32_16x16x32_bf16 v[64:67], v[132:135], v[124:127], v[64:67]
    ds_read_b64_tr_b16 v[178:179], v41 offset:6432
    ds_read_b128 v[168:171], v40 offset:4352
    v_mfma_f32_16x16x32_bf16 v[68:71], v[132:135], v[128:131], v[68:71]
    ds_read_b64_tr_b16 v[180:181], v41 offset:5184
    ds_read_b64_tr_b16 v[182:183], v41 offset:6464
    v_mfma_f32_16x16x32_bf16 v[72:75], v[136:139], v[124:127], v[72:75]
    v_mfma_f32_16x16x32_bf16 v[76:79], v[136:139], v[128:131], v[76:79]
    v_mfma_f32_16x16x32_bf16 v[80:83], v[140:143], v[124:127], v[80:83]
    v_mfma_f32_16x16x32_bf16 v[84:87], v[140:143], v[128:131], v[84:87]
    s_add_u32 s56, s56, 18432
    s_cmp_eq_u32 s56, 147456
    s_cselect_b32 s56, 0, s56
    s_add_u32 s57, s57, 1
    v_add_u32 v40, s56, v42
    v_add_u32 v41, s56, v43
    s_cmp_eq_u32 s57, 27
    s_waitcnt lgkmcnt(0)
    s_barrier
    v_mfma_f32_16x16x32_bf16 v[64:67], v[152:155], v[144:147], v[64:67]
    ds_read_b64_tr_b16 v[112:113], v41 offset:0
    ds_read_b64_tr_b16 v[114:115], v41 offset:1280
    v_mfma_f32_16x16x32_bf16 v[68:71], v[152:155], v[148:151], v[68:71]
    ds_read_b128 v[104:107], v40 offset:0
    ds_read_b64_tr_b16 v[116:117], v41 offset:32
    v_mfma_f32_16x16x32_bf16 v[72:75], v[156:159], v[144:147], v[72:75]
    ds_read_b64_tr_b16 v[118:119], v41 offset:1312
    ds_read_b128 v[108:111], v40 offset:256
    v_mfma_f32_16x16x32_bf16 v[76:79], v[156:159], v[148:151], v[76:79]
    ds_read_b64_tr_b16 v[120:121], v41 offset:64
    ds_read_b64_tr_b16 v[122:123], v41 offset:1344
    v_mfma_f32_16x16x32_bf16 v[80:83], v[160:163], v[144:147], v[80:83]
    ds_read_b64_tr_b16 v[132:133], v41 offset:5120
    ds_read_b64_tr_b16 v[134:135], v41 offset:6400
    v_mfma_f32_16x16x32_bf16 v[84:87], v[160:163], v[148:151], v[84:87]
    ds_read_b128 v[124:127], v40 offset:4096
    ds_read_b64_tr_b16 v[136:137], v41 offset:5152
    v_mfma_f32_16x16x32_bf16 v[64:67], v[172:175], v[164:167], v[64:67]
    ds_read_b64_tr_b16 v[138:139], v41 offset:6432
    ds_read_b128 v[128:131], v40 offset:4352
    v_mfma_f32_16x16x32_bf16 v[68:71], v[172:175], v[168:171], v[68:71]
    ds_read_b64_tr_b16 v[140:141], v41 offset:5184
    ds_read_b64_tr_b16 v[142:143], v41 offset:6464
    v_mfma_f32_16x16x32_bf16 v[72:75], v[176:179], v[164:167], v[72:75]
    v_mfma_f32_16x16x32_bf16 v[76:79], v[176:179], v[168:171], v[76:79]
    v_mfma_f32_16x16x32_bf16 v[80:83], v[180:183], v[164:167], v[80:83]
    v_mfma_f32_16x16x32_bf16 v[84:87], v[180:183], v[168:171], v[84:87]
    s_branch Lg80c_151
Lg80x_152:
    s_waitcnt lgkmcnt(0)
    v_mfma_f32_16x16x32_bf16 v[64:67], v[112:115], v[104:107], v[64:67]
    v_mfma_f32_16x16x32_bf16 v[68:71], v[112:115], v[108:111], v[68:71]
    v_mfma_f32_16x16x32_bf16 v[72:75], v[116:119], v[104:107], v[72:75]
    v_mfma_f32_16x16x32_bf16 v[76:79], v[116:119], v[108:111], v[76:79]
    v_mfma_f32_16x16x32_bf16 v[80:83], v[120:123], v[104:107], v[80:83]
    v_mfma_f32_16x16x32_bf16 v[84:87], v[120:123], v[108:111], v[84:87]
    v_mfma_f32_16x16x32_bf16 v[64:67], v[132:135], v[124:127], v[64:67]
    v_mfma_f32_16x16x32_bf16 v[68:71], v[132:135], v[128:131], v[68:71]
    v_mfma_f32_16x16x32_bf16 v[72:75], v[136:139], v[124:127], v[72:75]
    v_mfma_f32_16x16x32_bf16 v[76:79], v[136:139], v[128:131], v[76:79]
    v_mfma_f32_16x16x32_bf16 v[80:83], v[140:143], v[124:127], v[80:83]
    v_mfma_f32_16x16x32_bf16 v[84:87], v[140:143], v[128:131], v[84:87]
    s_waitcnt vmcnt(0) lgkmcnt(0)
    s_cmp_lg_u32 s55, 0
    s_cbranch_scc1 Lskipst_155
    v_cvt_pk_bf16_f32 v8, v64, v65
    v_cvt_pk_bf16_f32 v9, v66, v67
    v_cvt_pk_bf16_f32 v10, v68, v69
    v_cvt_pk_bf16_f32 v11, v70, v71
    s_nop 0
    v_permlane16_swap_b32 v8, v10
    v_permlane16_swap_b32 v9, v11
    buffer_store_dwordx4 v[8:11], v46, s[20:23], s60 offen offset:0
Lskipst_155:
    s_nop 1
    v_cvt_pk_bf16_f32 v12, v72, v73
    v_cvt_pk_bf16_f32 v13, v74, v75
    v_cvt_pk_bf16_f32 v14, v76, v77
    v_cvt_pk_bf16_f32 v15, v78, v79
    s_nop 0
    v_permlane16_swap_b32 v12, v14
    v_permlane16_swap_b32 v13, v15
    buffer_store_dwordx4 v[12:15], v46, s[20:23], s60 offen offset:32
    v_cvt_pk_bf16_f32 v16, v80, v81
    v_cvt_pk_bf16_f32 v17, v82, v83
    v_cvt_pk_bf16_f32 v18, v84, v85
    v_cvt_pk_bf16_f32 v19, v86, v87
    s_nop 0
    v_permlane16_swap_b32 v16, v18
    v_permlane16_swap_b32 v17, v19
    buffer_store_dwordx4 v[16:19], v46, s[20:23], s60 offen offset:64
    s_branch Lp6_147
Lp5ld_146:
    s_sub_u32 s31, s30, 4
    v_lshlrev_b32 v10, 4, v0
    v_add_u32 v11, 31744, v10
    s_lshl_b32 s52, s31, 11
    v_add_u32 v12, s52, v10
    s_lshl_b32 s52, s31, 9
    s_add_u32 s52, s52, 8192
    v_add_u32 v13, s52, v10
    s_lshl_b32 s54, s31, 16
    s_lshl_b32 s52, s28, 11
    s_add_u32 s54, s54, s52
    s_and_b32 s52, s29, 1
    s_lshl_b32 s52, s52, 10
    s_add_u32 s54, s54, s52
    s_add_u32 s54, s54, 19922944
    s_lshr_b32 s52, s29, 1
    s_mul_i32 s55, s52, 276480
    s_add_u32 s55, s55, 2097152
    s_mov_b32 s56, 0
    s_lshl_b32 s58, s31, 11
    s_lshl_b32 s59, s31, 9
    s_add_u32 s59, s59, 16384
    s_add_u32 s60, s58, 8192
    s_mul_i32 s52, s31, 3072
    s_lshl_b32 s53, s31, 11
    s_add_u32 s53, s53, 2048
    s_cmp_lt_u32 s31, 2
    s_cselect_b32 s52, s52, s53
    v_add_u32 v12, s52, v10
    s_add_u32 s60, s52, 8192
    s_cmp_lt_u32 s31, 2
    s_cbranch_scc0 Lg80rb_156
    s_mov_b32 s57, 0
Lg80w_158:
    s_add_u32 m0, s56, s60
    s_nop 0
    buffer_load_dwordx4 v12, s[16:19], s55 offen offset:0 sc1 lds
    buffer_load_dwordx4 v12, s[16:19], s55 offen offset:1024 sc1 lds
    buffer_load_dwordx4 v12, s[16:19], s55 offen offset:2048 sc1 lds
    s_add_u32 s55, s55, 10240
    s_add_u32 s56, s56, 18432
    s_add_u32 s57, s57, 1
    s_cmp_lt_u32 s57, 7
    s_cbranch_scc1 Lg80w_158
    s_cmp_lg_u32 s30, 0
    s_cbranch_scc1 Lnopoll_159
    v_and_b32 v3, 15, v0
    s_lshl_b32 s52, s28, 6
    s_add_u32 s52, s52, 48
    v_add_u32 v2, s52, v3
    v_mul_u32_u24 v2, 128, v2
    v_add_u32 v2, 131072, v2
    v_cmp_gt_u32 vcc, 14, v3
    s_nop 1
    v_cndmask_b32 v3, 0, 1, vcc
    s_mov_b32 s52, 40000
Lpoll_160:
    buffer_load_dword v1, v2, s[16:19], 0 offen sc1
    s_waitcnt vmcnt(0)
    v_cmp_le_u32 vcc, v3, v1
    s_cmp_eq_u64 vcc, -1
    s_cbranch_scc1 Lpolld_161
    s_sleep 1
    s_sub_u32 s52, s52, 1
    s_cmp_lg_u32 s52, 0
    s_cbranch_scc1 Lpoll_160
Lpolld_161:
Lnopoll_159:
    s_barrier
    s_mov_b32 s56, 0
Lg80xx_162:
    s_add_u32 m0, s56, s58
    s_nop 0
    buffer_load_dwordx4 v10, s[16:19], s54 offen sc1 lds
    buffer_load_dwordx4 v11, s[16:19], s54 offen offset:1024 sc1 lds
    s_add_u32 s54, s54, 262144
    s_add_u32 s56, s56, 18432
    s_cmp_lt_u32 s56, 129024
    s_cbranch_scc1 Lg80xx_162
    s_waitcnt vmcnt(12)
    s_barrier
    s_add_u32 m0, s56, s58
    s_nop 0
    buffer_load_dwordx4 v10, s[16:19], s54 offen sc1 lds
    buffer_load_dwordx4 v11, s[16:19], s54 offen offset:1024 sc1 lds
    s_add_u32 m0, s56, s60
    s_nop 0
    buffer_load_dwordx4 v12, s[16:19], s55 offen offset:0 sc1 lds
    buffer_load_dwordx4 v12, s[16:19], s55 offen offset:1024 sc1 lds
    buffer_load_dwordx4 v12, s[16:19], s55 offen offset:2048 sc1 lds
    s_add_u32 s54, s54, 262144
    s_add_u32 s55, s55, 10240
    s_add_u32 s56, s56, 18432
    s_cmp_eq_u32 s56, 147456
    s_cselect_b32 s56, 0, s56
    s_waitcnt vmcnt(15)
    s_barrier
    s_add_u32 m0, s56, s58
    s_nop 0
    buffer_load_dwordx4 v10, s[16:19], s54 offen sc1 lds
    buffer_load_dwordx4 v11, s[16:19], s54 offen offset:1024 sc1 lds
    s_add_u32 m0, s56, s60
    s_nop 0
    buffer_load_dwordx4 v12, s[16:19], s55 offen offset:0 sc1 lds
    buffer_load_dwordx4 v12, s[16:19], s55 offen offset:1024 sc1 lds
    buffer_load_dwordx4 v12, s[16:19], s55 offen offset:2048 sc1 lds
    s_add_u32 s54, s54, 262144
    s_add_u32 s55, s55, 10240
    s_add_u32 s56, s56, 18432
    s_cmp_eq_u32 s56, 147456
    s_cselect_b32 s56, 0, s56
    s_waitcnt vmcnt(18)
    s_barrier
    s_add_u32 m0, s56, s58
    s_nop 0
    buffer_load_dwordx4 v10, s[16:19], s54 offen sc1 lds
    buffer_load_dwordx4 v11, s[16:19], s54 offen offset:1024 sc1 lds
    s_add_u32 m0, s56, s60
    s_nop 0
    buffer_load_dwordx4 v12, s[16:19], s55 offen offset:0 sc1 lds
    buffer_load_dwordx4 v12, s[16:19], s55 offen offset:1024 sc1 lds
    buffer_load_dwordx4 v12, s[16:19], s55 offen offset:2048 sc1 lds
    s_add_u32 s54, s54, 262144
    s_add_u32 s55, s55, 10240
    s_add_u32 s56, s56, 18432
    s_cmp_eq_u32 s56, 147456
    s_cselect_b32 s56, 0, s56
    s_waitcnt vmcnt(21)
    s_barrier
    s_add_u32 m0, s56, s58
    s_nop 0
    buffer_load_dwordx4 v10, s[16:19], s54 offen sc1 lds
    buffer_load_dwordx4 v11, s[16:19], s54 offen offset:1024 sc1 lds
    s_add_u32 m0, s56, s60
    s_nop 0
    buffer_load_dwordx4 v12, s[16:19], s55 offen offset:0 sc1 lds
    buffer_load_dwordx4 v12, s[16:19], s55 offen offset:1024 sc1 lds
    buffer_load_dwordx4 v12, s[16:19], s55 offen offset:2048 sc1 lds
    s_add_u32 s54, s54, 262144
    s_add_u32 s55, s55, 10240
    s_add_u32 s56, s56, 18432
    s_cmp_eq_u32 s56, 147456
    s_cselect_b32 s56, 0, s56
    s_waitcnt vmcnt(24)
    s_barrier
    s_add_u32 m0, s56, s58
    s_nop 0
    buffer_load_dwordx4 v10, s[16:19], s54 offen sc1 lds
    buffer_load_dwordx4 v11, s[16:19], s54 offen offset:1024 sc1 lds
    s_add_u32 m0, s56, s60
    s_nop 0
    buffer_load_dwordx4 v12, s[16:19], s55 offen offset:0 sc1 lds
    buffer_load_dwordx4 v12, s[16:19], s55 offen offset:1024 sc1 lds
    buffer_load_dwordx4 v12, s[16:19], s55 offen offset:2048 sc1 lds
    s_add_u32 s54, s54, 262144
    s_add_u32 s55, s55, 10240
    s_add_u32 s56, s56, 18432
    s_cmp_eq_u32 s56, 147456
    s_cselect_b32 s56, 0, s56
    s_waitcnt vmcnt(27)
    s_barrier
    s_add_u32 m0, s56, s58
    s_nop 0
    buffer_load_dwordx4 v10, s[16:19], s54 offen sc1 lds
    buffer_load_dwordx4 v11, s[16:19], s54 offen offset:1024 sc1 lds
    s_add_u32 m0, s56, s60
    s_nop 0
    buffer_load_dwordx4 v12, s[16:19], s55 offen offset:0 sc1 lds
    buffer_load_dwordx4 v12, s[16:19], s55 offen offset:1024 sc1 lds
    buffer_load_dwordx4 v12, s[16:19], s55 offen offset:2048 sc1 lds
    s_add_u32 s54, s54, 262144
    s_add_u32 s55, s55, 10240
    s_add_u32 s56, s56, 18432
    s_cmp_eq_u32 s56, 147456
    s_cselect_b32 s56, 0, s56
    s_mov_b32 s57, 14
Lg80m_163:
    s_waitcnt vmcnt(30)
    s_barrier
    s_add_u32 m0, s56, s58
    s_nop 0
    buffer_load_dwordx4 v10, s[16:19], s54 offen sc1 lds
    buffer_load_dwordx4 v11, s[16:19], s54 offen offset:1024 sc1 lds
    s_add_u32 m0, s56, s60
    s_nop 0
    buffer_load_dwordx4 v12, s[16:19], s55 offen offset:0 sc1 lds
    buffer_load_dwordx4 v12, s[16:19], s55 offen offset:1024 sc1 lds
    buffer_load_dwordx4 v12, s[16:19], s55 offen offset:2048 sc1 lds
    s_add_u32 s54, s54, 262144
    s_add_u32 s55, s55, 10240
    s_add_u32 s56, s56, 18432
    s_cmp_eq_u32 s56, 147456
    s_cselect_b32 s56, 0, s56
    s_sub_u32 s57, s57, 1
    s_cmp_lg_u32 s57, 0
    s_cbranch_scc1 Lg80m_163
    s_waitcnt vmcnt(30)
    s_barrier
    s_waitcnt vmcnt(25)
    s_barrier
    s_waitcnt vmcnt(20)
    s_barrier
    s_waitcnt vmcnt(15)
    s_barrier
    s_waitcnt vmcnt(10)
    s_barrier
    s_waitcnt vmcnt(5)
    s_barrier
    s_waitcnt vmcnt(0)
    s_barrier
    s_branch Lg80re_157
Lg80rb_156:
    s_mov_b32 s57, 0
Lg80w_164:
    s_add_u32 m0, s56, s60
    s_nop 0
    buffer_load_dwordx4 v12, s[16:19], s55 offen offset:0 sc1 lds
    buffer_load_dwordx4 v12, s[16:19], s55 offen offset:1024 sc1 lds
    s_add_u32 s55, s55, 10240
    s_add_u32 s56, s56, 18432
    s_add_u32 s57, s57, 1
    s_cmp_lt_u32 s57, 7
    s_cbranch_scc1 Lg80w_164
    s_cmp_lg_u32 s30, 0
    s_cbranch_scc1 Lnopoll_165
    v_and_b32 v3, 15, v0
    s_lshl_b32 s52, s28, 6
    s_add_u32 s52, s52, 48
    v_add_u32 v2, s52, v3
    v_mul_u32_u24 v2, 128, v2
    v_add_u32 v2, 131072, v2
    v_cmp_gt_u32 vcc, 14, v3
    s_nop 1
    v_cndmask_b32 v3, 0, 1, vcc
    s_mov_b32 s52, 40000
Lpoll_166:
    buffer_load_dword v1, v2, s[16:19], 0 offen sc1
    s_waitcnt vmcnt(0)
    v_cmp_le_u32 vcc, v3, v1
    s_cmp_eq_u64 vcc, -1
    s_cbranch_scc1 Lpolld_167
    s_sleep 1
    s_sub_u32 s52, s52, 1
    s_cmp_lg_u32 s52, 0
    s_cbranch_scc1 Lpoll_166
Lpolld_167:
Lnopoll_165:
    s_barrier
    s_mov_b32 s56, 0
Lg80xx_168:
    s_add_u32 m0, s56, s58
    s_nop 0
    buffer_load_dwordx4 v10, s[16:19], s54 offen sc1 lds
    buffer_load_dwordx4 v11, s[16:19], s54 offen offset:1024 sc1 lds
    s_add_u32 s54, s54, 262144
    s_add_u32 s56, s56, 18432
    s_cmp_lt_u32 s56, 129024
    s_cbranch_scc1 Lg80xx_168
    s_waitcnt vmcnt(12)
    s_barrier
    s_add_u32 m0, s56, s58
    s_nop 0
    buffer_load_dwordx4 v10, s[16:19], s54 offen sc1 lds
    buffer_load_dwordx4 v11, s[16:19], s54 offen offset:1024 sc1 lds
    s_add_u32 m0, s56, s60
    s_nop 0
    buffer_load_dwordx4 v12, s[16:19], s55 offen offset:0 sc1 lds
    buffer_load_dwordx4 v12, s[16:19], s55 offen offset:1024 sc1 lds
    s_add_u32 s54, s54, 262144
    s_add_u32 s55, s55, 10240
    s_add_u32 s56, s56, 18432
    s_cmp_eq_u32 s56, 147456
    s_cselect_b32 s56, 0, s56
    s_waitcnt vmcnt(14)
    s_barrier
    s_add_u32 m0, s56, s58
    s_nop 0
    buffer_load_dwordx4 v10, s[16:19], s54 offen sc1 lds
    buffer_load_dwordx4 v11, s[16:19], s54 offen offset:1024 sc1 lds
    s_add_u32 m0, s56, s60
    s_nop 0
    buffer_load_dwordx4 v12, s[16:19], s55 offen offset:0 sc1 lds
    buffer_load_dwordx4 v12, s[16:19], s55 offen offset:1024 sc1 lds
    s_add_u32 s54, s54, 262144
    s_add_u32 s55, s55, 10240
    s_add_u32 s56, s56, 18432
    s_cmp_eq_u32 s56, 147456
    s_cselect_b32 s56, 0, s56
    s_waitcnt vmcnt(16)
    s_barrier
    s_add_u32 m0, s56, s58
    s_nop 0
    buffer_load_dwordx4 v10, s[16:19], s54 offen sc1 lds
    buffer_load_dwordx4 v11, s[16:19], s54 offen offset:1024 sc1 lds
    s_add_u32 m0, s56, s60
    s_nop 0
    buffer_load_dwordx4 v12, s[16:19], s55 offen offset:0 sc1 lds
    buffer_load_dwordx4 v12, s[16:19], s55 offen offset:1024 sc1 lds
    s_add_u32 s54, s54, 262144
    s_add_u32 s55, s55, 10240
    s_add_u32 s56, s56, 18432
    s_cmp_eq_u32 s56, 147456
    s_cselect_b32 s56, 0, s56
    s_waitcnt vmcnt(18)
    s_barrier
    s_add_u32 m0, s56, s58
    s_nop 0
    buffer_load_dwordx4 v10, s[16:19], s54 offen sc1 lds
    buffer_load_dwordx4 v11, s[16:19], s54 offen offset:1024 sc1 lds
    s_add_u32 m0, s56, s60
    s_nop 0
    buffer_load_dwordx4 v12, s[16:19], s55 offen offset:0 sc1 lds
    buffer_load_dwordx4 v12, s[16:19], s55 offen offset:1024 sc1 lds
    s_add_u32 s54, s54, 262144
    s_add_u32 s55, s55, 10240
    s_add_u32 s56, s56, 18432
    s_cmp_eq_u32 s56, 147456
    s_cselect_b32 s56, 0, s56
    s_waitcnt vmcnt(20)
    s_barrier
    s_add_u32 m0, s56, s58
    s_nop 0
    buffer_load_dwordx4 v10, s[16:19], s54 offen sc1 lds
    buffer_load_dwordx4 v11, s[16:19], s54 offen offset:1024 sc1 lds
    s_add_u32 m0, s56, s60
    s_nop 0
    buffer_load_dwordx4 v12, s[16:19], s55 offen offset:0 sc1 lds
    buffer_load_dwordx4 v12, s[16:19], s55 offen offset:1024 sc1 lds
    s_add_u32 s54, s54, 262144
    s_add_u32 s55, s55, 10240
    s_add_u32 s56, s56, 18432
    s_cmp_eq_u32 s56, 147456
    s_cselect_b32 s56, 0, s56
    s_waitcnt vmcnt(22)
    s_barrier
    s_add_u32 m0, s56, s58
    s_nop 0
    buffer_load_dwordx4 v10, s[16:19], s54 offen sc1 lds
    buffer_load_dwordx4 v11, s[16:19], s54 offen offset:1024 sc1 lds
    s_add_u32 m0, s56, s60
    s_nop 0
    buffer_load_dwordx4 v12, s[16:19], s55 offen offset:0 sc1 lds
    buffer_load_dwordx4 v12, s[16:19], s55 offen offset:1024 sc1 lds
    s_add_u32 s54, s54, 262144
    s_add_u32 s55, s55, 10240
    s_add_u32 s56, s56, 18432
    s_cmp_eq_u32 s56, 147456
    s_cselect_b32 s56, 0, s56
    s_mov_b32 s57, 14
Lg80m_169:
    s_waitcnt vmcnt(24)
    s_barrier
    s_add_u32 m0, s56, s58
    s_nop 0
    buffer_load_dwordx4 v10, s[16:19], s54 offen sc1 lds
    buffer_load_dwordx4 v11, s[16:19], s54 offen offset:1024 sc1 lds
    s_add_u32 m0, s56, s60
    s_nop 0
    buffer_load_dwordx4 v12, s[16:19], s55 offen offset:0 sc1 lds
    buffer_load_dwordx4 v12, s[16:19], s55 offen offset:1024 sc1 lds
    s_add_u32 s54, s54, 262144
    s_add_u32 s55, s55, 10240
    s_add_u32 s56, s56, 18432
    s_cmp_eq_u32 s56, 147456
    s_cselect_b32 s56, 0, s56
    s_sub_u32 s57, s57, 1
    s_cmp_lg_u32 s57, 0
    s_cbranch_scc1 Lg80m_169
    s_waitcnt vmcnt(24)
    s_barrier
    s_waitcnt vmcnt(20)
    s_barrier
    s_waitcnt vmcnt(16)
    s_barrier
    s_waitcnt vmcnt(12)
    s_barrier
    s_waitcnt vmcnt(8)
    s_barrier
    s_waitcnt vmcnt(4)
    s_barrier
    s_waitcnt vmcnt(0)
    s_barrier
Lg80re_157:
Lp6_147:
Lend:
    s_endpgm
Lsfx_21:
    s_cmp_eq_u32 s60, 2
    s_cbranch_scc1 Lsfo_19
    s_cmp_eq_u32 s60, 0
    s_cbranch_scc1 Lsfp_20
    s_waitcnt vmcnt(0)
    v_readfirstlane_b32 s62, v196
    s_nop 3
    s_cmp_eq_u32 s62, 1
    s_cbranch_scc0 Lsfp_20
    buffer_load_dwordx2 v[192:193], v197, s[16:19], s61 offen sc1
    buffer_load_dwordx2 v[194:195], v197, s[16:19], s61 offen offset:256 sc1
    s_mov_b32 s60, 2
    s_branch Lsfo_19
Lsfp_20:
    buffer_load_dword v196, off, s[24:27], s63 sc1
    s_mov_b32 s60, 1
    s_branch Lsfo_19
Lfinv_41:
    v_mov_b32 v64, s57
    v_mov_b32 v65, s57
    v_mov_b32 v66, s57
    v_mov_b32 v67, s57
    v_mov_b32 v68, s57
    v_mov_b32 v69, s57
    v_mov_b32 v70, s57
    v_mov_b32 v71, s57
    v_mov_b32 v72, s57
    v_mov_b32 v73, s57
    v_mov_b32 v74, s57
    v_mov_b32 v75, s57
    v_mov_b32 v76, s57
    v_mov_b32 v77, s57
    v_mov_b32 v78, s57
    v_mov_b32 v79, s57
    s_branch Lfinvb_42
Lfinv_43:
    v_mov_b32 v80, s57
    v_mov_b32 v81, s57
    v_mov_b32 v82, s57
    v_mov_b32 v83, s57
    v_mov_b32 v84, s57
    v_mov_b32 v85, s57
    v_mov_b32 v86, s57
    v_mov_b32 v87, s57
    v_mov_b32 v88, s57
    v_mov_b32 v89, s57
    v_mov_b32 v90, s57
    v_mov_b32 v91, s57
    v_mov_b32 v92, s57
    v_mov_b32 v93, s57
    v_mov_b32 v94, s57
    v_mov_b32 v95, s57
    s_branch Lfinvb_44
Lfinv_46:
    v_mov_b32 v64, s57
    v_mov_b32 v65, s57
    v_mov_b32 v66, s57
    v_mov_b32 v67, s57
    v_mov_b32 v68, s57
    v_mov_b32 v69, s57
    v_mov_b32 v70, s57
    v_mov_b32 v71, s57
    v_mov_b32 v72, s57
    v_mov_b32 v73, s57
    v_mov_b32 v74, s57
    v_mov_b32 v75, s57
    v_mov_b32 v76, s57
    v_mov_b32 v77, s57
    v_mov_b32 v78, s57
    v_mov_b32 v79, s57
    s_branch Lfinvb_47
Lfinv_48:
    v_mov_b32 v80, s57
    v_mov_b32 v81, s57
    v_mov_b32 v82, s57
    v_mov_b32 v83, s57
    v_mov_b32 v84, s57
    v_mov_b32 v85, s57
    v_mov_b32 v86, s57
    v_mov_b32 v87, s57
    v_mov_b32 v88, s57
    v_mov_b32 v89, s57
    v_mov_b32 v90, s57
    v_mov_b32 v91, s57
    v_mov_b32 v92, s57
    v_mov_b32 v93, s57
    v_mov_b32 v94, s57
    v_mov_b32 v95, s57
    s_branch Lfinvb_49
Lfinv_50:
    v_mov_b32 v64, s57
    v_mov_b32 v65, s57
    v_mov_b32 v66, s57
    v_mov_b32 v67, s57
    v_mov_b32 v68, s57
    v_mov_b32 v69, s57
    v_mov_b32 v70, s57
    v_mov_b32 v71, s57
    v_mov_b32 v72, s57
    v_mov_b32 v73, s57
    v_mov_b32 v74, s57
    v_mov_b32 v75, s57
    v_mov_b32 v76, s57
    v_mov_b32 v77, s57
    v_mov_b32 v78, s57
    v_mov_b32 v79, s57
    s_branch Lfinvb_51
Lfinv_52:
    v_mov_b32 v80, s57
    v_mov_b32 v81, s57
    v_mov_b32 v82, s57
    v_mov_b32 v83, s57
    v_mov_b32 v84, s57
    v_mov_b32 v85, s57
    v_mov_b32 v86, s57
    v_mov_b32 v87, s57
    v_mov_b32 v88, s57
    v_mov_b32 v89, s57
    v_mov_b32 v90, s57
    v_mov_b32 v91, s57
    v_mov_b32 v92, s57
    v_mov_b32 v93, s57
    v_mov_b32 v94, s57
    v_mov_b32 v95, s57
    s_branch Lfinvb_53
Lfinv_54:
    v_mov_b32 v64, s57
    v_mov_b32 v65, s57
    v_mov_b32 v66, s57
    v_mov_b32 v67, s57
    v_mov_b32 v68, s57
    v_mov_b32 v69, s57
    v_mov_b32 v70, s57
    v_mov_b32 v71, s57
    v_mov_b32 v72, s57
    v_mov_b32 v73, s57
    v_mov_b32 v74, s57
    v_mov_b32 v75, s57
    v_mov_b32 v76, s57
    v_mov_b32 v77, s57
    v_mov_b32 v78, s57
    v_mov_b32 v79, s57
    s_branch Lfinvb_55
Lfinv_56:
    v_mov_b32 v80, s57
    v_mov_b32 v81, s57
    v_mov_b32 v82, s57
    v_mov_b32 v83, s57
    v_mov_b32 v84, s57
    v_mov_b32 v85, s57
    v_mov_b32 v86, s57
    v_mov_b32 v87, s57
    v_mov_b32 v88, s57
    v_mov_b32 v89, s57
    v_mov_b32 v90, s57
    v_mov_b32 v91, s57
    v_mov_b32 v92, s57
    v_mov_b32 v93, s57
    v_mov_b32 v94, s57
    v_mov_b32 v95, s57
    s_branch Lfinvb_57
Linv_58:
    v_mov_b32 v64, s57
    v_mov_b32 v65, s57
    v_mov_b32 v66, s57
    v_mov_b32 v67, s57
    v_mov_b32 v68, s57
    v_mov_b32 v69, s57
    v_mov_b32 v70, s57
    v_mov_b32 v71, s57
    v_mov_b32 v72, s57
    v_mov_b32 v73, s57
    v_mov_b32 v74, s57
    v_mov_b32 v75, s57
    v_mov_b32 v76, s57
    v_mov_b32 v77, s57
    v_mov_b32 v78, s57
    v_mov_b32 v79, s57
    s_branch Linvb_59
Linv_60:
    v_mov_b32 v80, s57
    v_mov_b32 v81, s57
    v_mov_b32 v82, s57
    v_mov_b32 v83, s57
    v_mov_b32 v84, s57
    v_mov_b32 v85, s57
    v_mov_b32 v86, s57
    v_mov_b32 v87, s57
    v_mov_b32 v88, s57
    v_mov_b32 v89, s57
    v_mov_b32 v90, s57
    v_mov_b32 v91, s57
    v_mov_b32 v92, s57
    v_mov_b32 v93, s57
    v_mov_b32 v94, s57
    v_mov_b32 v95, s57
    s_branch Linvb_61
Linv_62:
    v_mov_b32 v96, s57
    v_mov_b32 v97, s57
    v_mov_b32 v98, s57
    v_mov_b32 v99, s57
    v_mov_b32 v100, s57
    v_mov_b32 v101, s57
    v_mov_b32 v102, s57
    v_mov_b32 v103, s57
    v_mov_b32 v104, s57
    v_mov_b32 v105, s57
    v_mov_b32 v106, s57
    v_mov_b32 v107, s57
    v_mov_b32 v108, s57
    v_mov_b32 v109, s57
    v_mov_b32 v110, s57
    v_mov_b32 v111, s57
    s_branch Linvb_63
Linv_64:
    v_mov_b32 v112, s57
    v_mov_b32 v113, s57
    v_mov_b32 v114, s57
    v_mov_b32 v115, s57
    v_mov_b32 v116, s57
    v_mov_b32 v117, s57
    v_mov_b32 v118, s57
    v_mov_b32 v119, s57
    v_mov_b32 v120, s57
    v_mov_b32 v121, s57
    v_mov_b32 v122, s57
    v_mov_b32 v123, s57
    v_mov_b32 v124, s57
    v_mov_b32 v125, s57
    v_mov_b32 v126, s57
    v_mov_b32 v127, s57
    s_branch Linvb_65
Linv_66:
    v_mov_b32 v128, s57
    v_mov_b32 v129, s57
    v_mov_b32 v130, s57
    v_mov_b32 v131, s57
    v_mov_b32 v132, s57
    v_mov_b32 v133, s57
    v_mov_b32 v134, s57
    v_mov_b32 v135, s57
    v_mov_b32 v136, s57
    v_mov_b32 v137, s57
    v_mov_b32 v138, s57
    v_mov_b32 v139, s57
    v_mov_b32 v140, s57
    v_mov_b32 v141, s57
    v_mov_b32 v142, s57
    v_mov_b32 v143, s57
    s_branch Linvb_67
Linv_68:
    v_mov_b32 v144, s57
    v_mov_b32 v145, s57
    v_mov_b32 v146, s57
    v_mov_b32 v147, s57
    v_mov_b32 v148, s57
    v_mov_b32 v149, s57
    v_mov_b32 v150, s57
    v_mov_b32 v151, s57
    v_mov_b32 v152, s57
    v_mov_b32 v153, s57
    v_mov_b32 v154, s57
    v_mov_b32 v155, s57
    v_mov_b32 v156, s57
    v_mov_b32 v157, s57
    v_mov_b32 v158, s57
    v_mov_b32 v159, s57
    s_branch Linvb_69
Linv_70:
    v_mov_b32 v160, s57
    v_mov_b32 v161, s57
    v_mov_b32 v162, s57
    v_mov_b32 v163, s57
    v_mov_b32 v164, s57
    v_mov_b32 v165, s57
    v_mov_b32 v166, s57
    v_mov_b32 v167, s57
    v_mov_b32 v168, s57
    v_mov_b32 v169, s57
    v_mov_b32 v170, s57
    v_mov_b32 v171, s57
    v_mov_b32 v172, s57
    v_mov_b32 v173, s57
    v_mov_b32 v174, s57
    v_mov_b32 v175, s57
    s_branch Linvb_71
Linv_72:
    v_mov_b32 v176, s57
    v_mov_b32 v177, s57
    v_mov_b32 v178, s57
    v_mov_b32 v179, s57
    v_mov_b32 v180, s57
    v_mov_b32 v181, s57
    v_mov_b32 v182, s57
    v_mov_b32 v183, s57
    v_mov_b32 v184, s57
    v_mov_b32 v185, s57
    v_mov_b32 v186, s57
    v_mov_b32 v187, s57
    v_mov_b32 v188, s57
    v_mov_b32 v189, s57
    v_mov_b32 v190, s57
    v_mov_b32 v191, s57
    s_branch Linvb_73
Lslow_39:
    ds_read_b128 v[232:235], v40 offset:0
    ds_read_b128 v[236:239], v41 offset:0
    ds_read_b128 v[240:243], v40 offset:512
    ds_read_b128 v[244:247], v41 offset:512
    s_waitcnt lgkmcnt(2)
    s_cmp_gt_i32 s52, 0
    s_cbranch_scc1 Linv_58
    v_mfma_f32_32x32x16_bf16 v[64:79], v[232:235], v[224:227], 0
    v_mfma_f32_32x32x16_bf16 v[64:79], v[236:239], v[228:231], v[64:79]
Linvb_59:
    ds_read_b128 v[232:235], v40 offset:1024
    ds_read_b128 v[236:239], v41 offset:1024
    s_waitcnt lgkmcnt(2)
    s_cmp_gt_i32 s52, 1
    s_cbranch_scc1 Linv_60
    v_mfma_f32_32x32x16_bf16 v[80:95], v[240:243], v[224:227], 0
    v_mfma_f32_32x32x16_bf16 v[80:95], v[244:247], v[228:231], v[80:95]
Linvb_61:
    ds_read_b128 v[240:243], v40 offset:1536
    ds_read_b128 v[244:247], v41 offset:1536
    s_waitcnt lgkmcnt(2)
    s_cmp_gt_i32 s52, 2
    s_cbranch_scc1 Linv_62
    v_mfma_f32_32x32x16_bf16 v[96:111], v[232:235], v[224:227], 0
    v_mfma_f32_32x32x16_bf16 v[96:111], v[236:239], v[228:231], v[96:111]
Linvb_63:
    s_nop 4
    v_max3_f32 v44, v80, v81, v82
    v_max3_f32 v45, v84, v85, v86
    v_max3_f32 v46, v88, v89, v90
    v_max3_f32 v47, v92, v93, v94
    v_max_f32 v44, v44, v83
    v_max_f32 v45, v45, v87
    v_max_f32 v46, v46, v91
    v_max_f32 v47, v47, v95
    ds_read_b128 v[232:235], v40 offset:2048
    ds_read_b128 v[236:239], v41 offset:2048
    s_waitcnt lgkmcnt(2)
    s_cmp_gt_i32 s52, 3
    s_cbranch_scc1 Linv_64
    v_mfma_f32_32x32x16_bf16 v[112:127], v[240:243], v[224:227], 0
    v_mfma_f32_32x32x16_bf16 v[112:127], v[244:247], v[228:231], v[112:127]
Linvb_65:
    v_max3_f32 v44, v96, v97, v44
    v_max3_f32 v45, v100, v101, v45
    v_max3_f32 v46, v104, v105, v46
    v_max3_f32 v47, v108, v109, v47
    v_max3_f32 v44, v98, v99, v44
    v_max3_f32 v45, v102, v103, v45
    v_max3_f32 v46, v106, v107, v46
    v_max3_f32 v47, v110, v111, v47
    ds_read_b128 v[240:243], v40 offset:2560
    ds_read_b128 v[244:247], v41 offset:2560
    s_waitcnt lgkmcnt(2)
    s_cmp_gt_i32 s52, 4
    s_cbranch_scc1 Linv_66
    v_mfma_f32_32x32x16_bf16 v[128:143], v[232:235], v[224:227], 0
    v_mfma_f32_32x32x16_bf16 v[128:143], v[236:239], v[228:231], v[128:143]
Linvb_67:
    v_max3_f32 v44, v112, v113, v44
    v_max3_f32 v45, v116, v117, v45
    v_max3_f32 v46, v120, v121, v46
    v_max3_f32 v47, v124, v125, v47
    v_max3_f32 v44, v114, v115, v44
    v_max3_f32 v45, v118, v119, v45
    v_max3_f32 v46, v122, v123, v46
    v_max3_f32 v47, v126, v127, v47
    ds_read_b128 v[232:235], v40 offset:3072
    ds_read_b128 v[236:239], v41 offset:3072
    s_waitcnt lgkmcnt(2)
    s_cmp_gt_i32 s52, 5
    s_cbranch_scc1 Linv_68
    v_mfma_f32_32x32x16_bf16 v[144:159], v[240:243], v[224:227], 0
    v_mfma_f32_32x32x16_bf16 v[144:159], v[244:247], v[228:231], v[144:159]
Linvb_69:
    v_max3_f32 v44, v128, v129, v44
    v_max3_f32 v45, v132, v133, v45
    v_max3_f32 v46, v136, v137, v46
    v_max3_f32 v47, v140, v141, v47
    v_max3_f32 v44, v130, v131, v44
    v_max3_f32 v45, v134, v135, v45
    v_max3_f32 v46, v138, v139, v46
    v_max3_f32 v47, v142, v143, v47
    ds_read_b128 v[240:243], v40 offset:3584
    ds_read_b128 v[244:247], v41 offset:3584
    s_waitcnt lgkmcnt(2)
    s_cmp_gt_i32 s52, 6
    s_cbranch_scc1 Linv_70
    v_mfma_f32_32x32x16_bf16 v[160:175], v[232:235], v[224:227], 0
    v_mfma_f32_32x32x16_bf16 v[160:175], v[236:239], v[228:231], v[160:175]
Linvb_71:
    v_max3_f32 v44, v144, v145, v44
    v_max3_f32 v45, v148, v149, v45
    v_max3_f32 v46, v152, v153, v46
    v_max3_f32 v47, v156, v157, v47
    v_max3_f32 v44, v146, v147, v44
    v_max3_f32 v45, v150, v151, v45
    v_max3_f32 v46, v154, v155, v46
    v_max3_f32 v47, v158, v159, v47
    ds_read_b128 v[232:235], v40 offset:4096
    ds_read_b128 v[236:239], v41 offset:4096
    s_waitcnt lgkmcnt(2)
    s_cmp_gt_i32 s52, 7
    s_cbranch_scc1 Linv_72
    v_mfma_f32_32x32x16_bf16 v[176:191], v[240:243], v[224:227], 0
    v_mfma_f32_32x32x16_bf16 v[176:191], v[244:247], v[228:231], v[176:191]
Linvb_73:
    v_max3_f32 v44, v160, v161, v44
    v_max3_f32 v45, v164, v165, v45
    v_max3_f32 v46, v168, v169, v46
    v_max3_f32 v47, v172, v173, v47
    v_max3_f32 v44, v162, v163, v44
    v_max3_f32 v45, v166, v167, v45
    v_max3_f32 v46, v170, v171, v46
    v_max3_f32 v47, v174, v175, v47
    s_waitcnt lgkmcnt(0)
    v_mfma_f32_32x32x16_bf16 v[192:207], v[232:235], v[224:227], 0
    v_mfma_f32_32x32x16_bf16 v[192:207], v[236:239], v[228:231], v[192:207]
    s_nop 0
    v_max3_f32 v44, v176, v177, v44
    v_max3_f32 v45, v180, v181, v45
    v_max3_f32 v46, v184, v185, v46
    v_max3_f32 v47, v188, v189, v47
    v_max3_f32 v44, v178, v179, v44
    v_max3_f32 v45, v182, v183, v45
    v_max3_f32 v46, v186, v187, v46
    v_max3_f32 v47, v190, v191, v47
    ds_read_b64_tr_b16 v[24:25], v42 offset:0
    ds_read_b64_tr_b16 v[26:27], v42 offset:128
    ds_read_b64_tr_b16 v[28:29], v42 offset:256
    ds_read_b64_tr_b16 v[30:31], v42 offset:384
    v_mov_b32 v48, s57
    v_cmp_gt_i32 s[60:61], 0, v43
    v_cmp_gt_i32 s[62:63], 1, v43
    v_cmp_gt_i32 s[64:65], 2, v43
    v_cmp_gt_i32 s[66:67], 3, v43
    v_cndmask_b32 v64, v48, v64, s[60:61]
    v_cndmask_b32 v192, v192, v48, s[60:61]
    v_cndmask_b32 v65, v48, v65, s[62:63]
    v_cndmask_b32 v193, v193, v48, s[62:63]
    v_cndmask_b32 v66, v48, v66, s[64:65]
    v_cndmask_b32 v194, v194, v48, s[64:65]
    v_cndmask_b32 v67, v48, v67, s[66:67]
    v_cndmask_b32 v195, v195, v48, s[66:67]
    v_cmp_gt_i32 s[60:61], 8, v43
    v_cmp_gt_i32 s[62:63], 9, v43
    v_cmp_gt_i32 s[64:65], 10, v43
    v_cmp_gt_i32 s[66:67], 11, v43
    v_cndmask_b32 v68, v48, v68, s[60:61]
    v_cndmask_b32 v196, v196, v48, s[60:61]
    v_cndmask_b32 v69, v48, v69, s[62:63]
    v_cndmask_b32 v197, v197, v48, s[62:63]
    v_cndmask_b32 v70, v48, v70, s[64:65]
    v_cndmask_b32 v198, v198, v48, s[64:65]
    v_cndmask_b32 v71, v48, v71, s[66:67]
    v_cndmask_b32 v199, v199, v48, s[66:67]
    v_cmp_gt_i32 s[60:61], 16, v43
    v_cmp_gt_i32 s[62:63], 17, v43
    v_cmp_gt_i32 s[64:65], 18, v43
    v_cmp_gt_i32 s[66:67], 19, v43
    v_cndmask_b32 v72, v48, v72, s[60:61]
    v_cndmask_b32 v200, v200, v48, s[60:61]
    v_cndmask_b32 v73, v48, v73, s[62:63]
    v_cndmask_b32 v201, v201, v48, s[62:63]
    v_cndmask_b32 v74, v48, v74, s[64:65]
    v_cndmask_b32 v202, v202, v48, s[64:65]
    v_cndmask_b32 v75, v48, v75, s[66:67]
    v_cndmask_b32 v203, v203, v48, s[66:67]
    v_cmp_gt_i32 s[60:61], 24, v43
    v_cmp_gt_i32 s[62:63], 25, v43
    v_cmp_gt_i32 s[64:65], 26, v43
    v_cmp_gt_i32 s[66:67], 27, v43
    v_cndmask_b32 v76, v48, v76, s[60:61]
    v_cndmask_b32 v204, v204, v48, s[60:61]
    v_cndmask_b32 v77, v48, v77, s[62:63]
    v_cndmask_b32 v205, v205, v48, s[62:63]
    v_cndmask_b32 v78, v48, v78, s[64:65]
    v_cndmask_b32 v206, v206, v48, s[64:65]
    v_cndmask_b32 v79, v48, v79, s[66:67]
    v_cndmask_b32 v207, v207, v48, s[66:67]
    v_max3_f32 v44, v64, v65, v44
    v_max3_f32 v45, v68, v69, v45
    v_max3_f32 v46, v72, v73, v46
    v_max3_f32 v47, v76, v77, v47
    v_max3_f32 v44, v66, v67, v44
    v_max3_f32 v45, v70, v71, v45
    v_max3_f32 v46, v74, v75, v46
    v_max3_f32 v47, v78, v79, v47
    v_max3_f32 v44, v192, v193, v44
    v_max3_f32 v45, v196, v197, v45
    v_max3_f32 v46, v200, v201, v46
    v_max3_f32 v47, v204, v205, v47
    v_max3_f32 v44, v194, v195, v44
    v_max3_f32 v45, v198, v199, v45
    v_max3_f32 v46, v202, v203, v46
    v_max3_f32 v47, v206, v207, v47
    v_max3_f32 v44, v44, v45, v46
    v_max_f32 v44, v44, v47
    v_mov_b32 v45, v44
    s_nop 1
    v_permlane32_swap_b32 v44, v45
    v_max_f32 v44, v44, v45
    v_sub_f32 v46, 0, v44
    ds_read_b64_tr_b16 v[32:33], v42 offset:512
    ds_read_b64_tr_b16 v[34:35], v42 offset:640
    ds_read_b64_tr_b16 v[36:37], v42 offset:768
    ds_read_b64_tr_b16 v[38:39], v42 offset:896
    v_pk_add_f32 v[64:65], v[64:65], v[46:47] op_sel_hi:[1,0]
    v_pk_add_f32 v[66:67], v[66:67], v[46:47] op_sel_hi:[1,0]
    v_pk_add_f32 v[68:69], v[68:69], v[46:47] op_sel_hi:[1,0]
    v_pk_add_f32 v[70:71], v[70:71], v[46:47] op_sel_hi:[1,0]
    v_exp_f32 v64, v64
    v_exp_f32 v65, v65
    v_exp_f32 v66, v66
    v_exp_f32 v67, v67
    v_exp_f32 v68, v68
    v_exp_f32 v69, v69
    v_exp_f32 v70, v70
    v_exp_f32 v71, v71
    v_cvt_pk_bf16_f32 v8, v64, v65
    v_cvt_pk_bf16_f32 v9, v66, v67
    v_cvt_pk_bf16_f32 v10, v68, v69
    v_cvt_pk_bf16_f32 v11, v70, v71
    s_waitcnt lgkmcnt(4)
    s_nop 0
    v_mfma_f32_32x32x16_bf16 v[208:223], v[24:27], v[8:11], 0
    v_pk_add_f32 v[72:73], v[72:73], v[46:47] op_sel_hi:[1,0]
    v_pk_add_f32 v[74:75], v[74:75], v[46:47] op_sel_hi:[1,0]
    v_pk_add_f32 v[76:77], v[76:77], v[46:47] op_sel_hi:[1,0]
    v_pk_add_f32 v[78:79], v[78:79], v[46:47] op_sel_hi:[1,0]
    v_exp_f32 v72, v72
    v_exp_f32 v73, v73
    v_exp_f32 v74, v74
    v_exp_f32 v75, v75
    v_exp_f32 v76, v76
    v_exp_f32 v77, v77
    v_exp_f32 v78, v78
    v_exp_f32 v79, v79
    v_cvt_pk_bf16_f32 v12, v72, v73
    v_cvt_pk_bf16_f32 v13, v74, v75
    v_cvt_pk_bf16_f32 v14, v76, v77
    v_cvt_pk_bf16_f32 v15, v78, v79
    s_nop 1
    v_mfma_f32_32x32x16_bf16 v[208:223], v[28:31], v[12:15], v[208:223]
    ds_read_b64_tr_b16 v[24:25], v42 offset:1024
    ds_read_b64_tr_b16 v[26:27], v42 offset:1152
    ds_read_b64_tr_b16 v[28:29], v42 offset:1280
    ds_read_b64_tr_b16 v[30:31], v42 offset:1408
    v_pk_add_f32 v[80:81], v[80:81], v[46:47] op_sel_hi:[1,0]
    v_pk_add_f32 v[82:83], v[82:83], v[46:47] op_sel_hi:[1,0]
    v_pk_add_f32 v[84:85], v[84:85], v[46:47] op_sel_hi:[1,0]
    v_pk_add_f32 v[86:87], v[86:87], v[46:47] op_sel_hi:[1,0]
    v_exp_f32 v80, v80
    v_exp_f32 v81, v81
    v_exp_f32 v82, v82
    v_exp_f32 v83, v83
    v_exp_f32 v84, v84
    v_exp_f32 v85, v85
    v_exp_f32 v86, v86
    v_exp_f32 v87, v87
    v_cvt_pk_bf16_f32 v16, v80, v81
    v_cvt_pk_bf16_f32 v17, v82, v83
    v_cvt_pk_bf16_f32 v18, v84, v85
    v_cvt_pk_bf16_f32 v19, v86, v87
    s_waitcnt lgkmcnt(4)
    s_nop 0
    v_mfma_f32_32x32x16_bf16 v[208:223], v[32:35], v[16:19], v[208:223]
    v_pk_add_f32 v[88:89], v[88:89], v[46:47] op_sel_hi:[1,0]
    v_pk_add_f32 v[90:91], v[90:91], v[46:47] op_sel_hi:[1,0]
    v_pk_add_f32 v[92:93], v[92:93], v[46:47] op_sel_hi:[1,0]
    v_pk_add_f32 v[94:95], v[94:95], v[46:47] op_sel_hi:[1,0]
    v_exp_f32 v88, v88
    v_exp_f32 v89, v89
    v_exp_f32 v90, v90
    v_exp_f32 v91, v91
    v_exp_f32 v92, v92
    v_exp_f32 v93, v93
    v_exp_f32 v94, v94
    v_exp_f32 v95, v95
    v_cvt_pk_bf16_f32 v20, v88, v89
    v_cvt_pk_bf16_f32 v21, v90, v91
    v_cvt_pk_bf16_f32 v22, v92, v93
    v_cvt_pk_bf16_f32 v23, v94, v95
    s_nop 1
    v_mfma_f32_32x32x16_bf16 v[208:223], v[36:39], v[20:23], v[208:223]
    ds_read_b64_tr_b16 v[32:33], v42 offset:1536
    ds_read_b64_tr_b16 v[34:35], v42 offset:1664
    ds_read_b64_tr_b16 v[36:37], v42 offset:1792
    ds_read_b64_tr_b16 v[38:39], v42 offset:1920
    v_pk_add_f32 v[96:97], v[96:97], v[46:47] op_sel_hi:[1,0]
    v_pk_add_f32 v[98:99], v[98:99], v[46:47] op_sel_hi:[1,0]
    v_pk_add_f32 v[100:101], v[100:101], v[46:47] op_sel_hi:[1,0]
    v_pk_add_f32 v[102:103], v[102:103], v[46:47] op_sel_hi:[1,0]
    v_exp_f32 v96, v96
    v_exp_f32 v97, v97
    v_exp_f32 v98, v98
    v_exp_f32 v99, v99
    v_exp_f32 v100, v100
    v_exp_f32 v101, v101
    v_exp_f32 v102, v102
    v_exp_f32 v103, v103
    v_cvt_pk_bf16_f32 v8, v96, v97
    v_cvt_pk_bf16_f32 v9, v98, v99
    v_cvt_pk_bf16_f32 v10, v100, v101
    v_cvt_pk_bf16_f32 v11, v102, v103
    s_waitcnt lgkmcnt(4)
    s_nop 0
    v_mfma_f32_32x32x16_bf16 v[208:223], v[24:27], v[8:11], v[208:223]
    v_pk_add_f32 v[104:105], v[104:105], v[46:47] op_sel_hi:[1,0]
    v_pk_add_f32 v[106:107], v[106:107], v[46:47] op_sel_hi:[1,0]
    v_pk_add_f32 v[108:109], v[108:109], v[46:47] op_sel_hi:[1,0]
    v_pk_add_f32 v[110:111], v[110:111], v[46:47] op_sel_hi:[1,0]
    v_exp_f32 v104, v104
    v_exp_f32 v105, v105
    v_exp_f32 v106, v106
    v_exp_f32 v107, v107
    v_exp_f32 v108, v108
    v_exp_f32 v109, v109
    v_exp_f32 v110, v110
    v_exp_f32 v111, v111
    v_cvt_pk_bf16_f32 v12, v104, v105
    v_cvt_pk_bf16_f32 v13, v106, v107
    v_cvt_pk_bf16_f32 v14, v108, v109
    v_cvt_pk_bf16_f32 v15, v110, v111
    s_nop 1
    v_mfma_f32_32x32x16_bf16 v[208:223], v[28:31], v[12:15], v[208:223]
    ds_read_b64_tr_b16 v[24:25], v42 offset:2048
    ds_read_b64_tr_b16 v[26:27], v42 offset:2176
    ds_read_b64_tr_b16 v[28:29], v42 offset:2304
    ds_read_b64_tr_b16 v[30:31], v42 offset:2432
    v_pk_add_f32 v[112:113], v[112:113], v[46:47] op_sel_hi:[1,0]
    v_pk_add_f32 v[114:115], v[114:115], v[46:47] op_sel_hi:[1,0]
    v_pk_add_f32 v[116:117], v[116:117], v[46:47] op_sel_hi:[1,0]
    v_pk_add_f32 v[118:119], v[118:119], v[46:47] op_sel_hi:[1,0]
    v_exp_f32 v112, v112
    v_exp_f32 v113, v113
    v_exp_f32 v114, v114
    v_exp_f32 v115, v115
    v_exp_f32 v116, v116
    v_exp_f32 v117, v117
    v_exp_f32 v118, v118
    v_exp_f32 v119, v119
    v_cvt_pk_bf16_f32 v16, v112, v113
    v_cvt_pk_bf16_f32 v17, v114, v115
    v_cvt_pk_bf16_f32 v18, v116, v117
    v_cvt_pk_bf16_f32 v19, v118, v119
    s_waitcnt lgkmcnt(4)
    s_nop 0
    v_mfma_f32_32x32x16_bf16 v[208:223], v[32:35], v[16:19], v[208:223]
    v_pk_add_f32 v[120:121], v[120:121], v[46:47] op_sel_hi:[1,0]
    v_pk_add_f32 v[122:123], v[122:123], v[46:47] op_sel_hi:[1,0]
    v_pk_add_f32 v[124:125], v[124:125], v[46:47] op_sel_hi:[1,0]
    v_pk_add_f32 v[126:127], v[126:127], v[46:47] op_sel_hi:[1,0]
    v_exp_f32 v120, v120
    v_exp_f32 v121, v121
    v_exp_f32 v122, v122
    v_exp_f32 v123, v123
    v_exp_f32 v124, v124
    v_exp_f32 v125, v125
    v_exp_f32 v126, v126
    v_exp_f32 v127, v127
    v_cvt_pk_bf16_f32 v20, v120, v121
    v_cvt_pk_bf16_f32 v21, v122, v123
    v_cvt_pk_bf16_f32 v22, v124, v125
    v_cvt_pk_bf16_f32 v23, v126, v127
    s_nop 1
    v_mfma_f32_32x32x16_bf16 v[208:223], v[36:39], v[20:23], v[208:223]
    ds_read_b64_tr_b16 v[32:33], v42 offset:2560
    ds_read_b64_tr_b16 v[34:35], v42 offset:2688
    ds_read_b64_tr_b16 v[36:37], v42 offset:2816
    ds_read_b64_tr_b16 v[38:39], v42 offset:2944
    v_pk_add_f32 v[128:129], v[128:129], v[46:47] op_sel_hi:[1,0]
    v_pk_add_f32 v[130:131], v[130:131], v[46:47] op_sel_hi:[1,0]
    v_pk_add_f32 v[132:133], v[132:133], v[46:47] op_sel_hi:[1,0]
    v_pk_add_f32 v[134:135], v[134:135], v[46:47] op_sel_hi:[1,0]
    v_exp_f32 v128, v128
    v_exp_f32 v129, v129
    v_exp_f32 v130, v130
    v_exp_f32 v131, v131
    v_exp_f32 v132, v132
    v_exp_f32 v133, v133
    v_exp_f32 v134, v134
    v_exp_f32 v135, v135
    v_cvt_pk_bf16_f32 v8, v128, v129
    v_cvt_pk_bf16_f32 v9, v130, v131
    v_cvt_pk_bf16_f32 v10, v132, v133
    v_cvt_pk_bf16_f32 v11, v134, v135
    s_waitcnt lgkmcnt(4)
    s_nop 0
    v_mfma_f32_32x32x16_bf16 v[208:223], v[24:27], v[8:11], v[208:223]
    v_pk_add_f32 v[136:137], v[136:137], v[46:47] op_sel_hi:[1,0]
    v_pk_add_f32 v[138:139], v[138:139], v[46:47] op_sel_hi:[1,0]
    v_pk_add_f32 v[140:141], v[140:141], v[46:47] op_sel_hi:[1,0]
    v_pk_add_f32 v[142:143], v[142:143], v[46:47] op_sel_hi:[1,0]
    v_exp_f32 v136, v136
    v_exp_f32 v137, v137
    v_exp_f32 v138, v138
    v_exp_f32 v139, v139
    v_exp_f32 v140, v140
    v_exp_f32 v141, v141
    v_exp_f32 v142, v142
    v_exp_f32 v143, v143
    v_cvt_pk_bf16_f32 v12, v136, v137
    v_cvt_pk_bf16_f32 v13, v138, v139
    v_cvt_pk_bf16_f32 v14, v140, v141
    v_cvt_pk_bf16_f32 v15, v142, v143
    s_nop 1
    v_mfma_f32_32x32x16_bf16 v[208:223], v[28:31], v[12:15], v[208:223]
    ds_read_b64_tr_b16 v[24:25], v42 offset:3072
    ds_read_b64_tr_b16 v[26:27], v42 offset:3200
    ds_read_b64_tr_b16 v[28:29], v42 offset:3328
    ds_read_b64_tr_b16 v[30:31], v42 offset:3456
    v_pk_add_f32 v[144:145], v[144:145], v[46:47] op_sel_hi:[1,0]
    v_pk_add_f32 v[146:147], v[146:147], v[46:47] op_sel_hi:[1,0]
    v_pk_add_f32 v[148:149], v[148:149], v[46:47] op_sel_hi:[1,0]
    v_pk_add_f32 v[150:151], v[150:151], v[46:47] op_sel_hi:[1,0]
    v_exp_f32 v144, v144
    v_exp_f32 v145, v145
    v_exp_f32 v146, v146
    v_exp_f32 v147, v147
    v_exp_f32 v148, v148
    v_exp_f32 v149, v149
    v_exp_f32 v150, v150
    v_exp_f32 v151, v151
    v_cvt_pk_bf16_f32 v16, v144, v145
    v_cvt_pk_bf16_f32 v17, v146, v147
    v_cvt_pk_bf16_f32 v18, v148, v149
    v_cvt_pk_bf16_f32 v19, v150, v151
    s_waitcnt lgkmcnt(4)
    s_nop 0
    v_mfma_f32_32x32x16_bf16 v[208:223], v[32:35], v[16:19], v[208:223]
    v_pk_add_f32 v[152:153], v[152:153], v[46:47] op_sel_hi:[1,0]
    v_pk_add_f32 v[154:155], v[154:155], v[46:47] op_sel_hi:[1,0]
    v_pk_add_f32 v[156:157], v[156:157], v[46:47] op_sel_hi:[1,0]
    v_pk_add_f32 v[158:159], v[158:159], v[46:47] op_sel_hi:[1,0]
    v_exp_f32 v152, v152
    v_exp_f32 v153, v153
    v_exp_f32 v154, v154
    v_exp_f32 v155, v155
    v_exp_f32 v156, v156
    v_exp_f32 v157, v157
    v_exp_f32 v158, v158
    v_exp_f32 v159, v159
    v_cvt_pk_bf16_f32 v20, v152, v153
    v_cvt_pk_bf16_f32 v21, v154, v155
    v_cvt_pk_bf16_f32 v22, v156, v157
    v_cvt_pk_bf16_f32 v23, v158, v159
    s_nop 1
    v_mfma_f32_32x32x16_bf16 v[208:223], v[36:39], v[20:23], v[208:223]
    ds_read_b64_tr_b16 v[32:33], v42 offset:3584
    ds_read_b64_tr_b16 v[34:35], v42 offset:3712
    ds_read_b64_tr_b16 v[36:37], v42 offset:3840
    ds_read_b64_tr_b16 v[38:39], v42 offset:3968
    v_pk_add_f32 v[160:161], v[160:161], v[46:47] op_sel_hi:[1,0]
    v_pk_add_f32 v[162:163], v[162:163], v[46:47] op_sel_hi:[1,0]
    v_pk_add_f32 v[164:165], v[164:165], v[46:47] op_sel_hi:[1,0]
    v_pk_add_f32 v[166:167], v[166:167], v[46:47] op_sel_hi:[1,0]
    v_exp_f32 v160, v160
    v_exp_f32 v161, v161
    v_exp_f32 v162, v162
    v_exp_f32 v163, v163
    v_exp_f32 v164, v164
    v_exp_f32 v165, v165
    v_exp_f32 v166, v166
    v_exp_f32 v167, v167
    v_cvt_pk_bf16_f32 v8, v160, v161
    v_cvt_pk_bf16_f32 v9, v162, v163
    v_cvt_pk_bf16_f32 v10, v164, v165
    v_cvt_pk_bf16_f32 v11, v166, v167
    s_waitcnt lgkmcnt(4)
    s_nop 0
    v_mfma_f32_32x32x16_bf16 v[208:223], v[24:27], v[8:11], v[208:223]
    v_pk_add_f32 v[168:169], v[168:169], v[46:47] op_sel_hi:[1,0]
    v_pk_add_f32 v[170:171], v[170:171], v[46:47] op_sel_hi:[1,0]
    v_pk_add_f32 v[172:173], v[172:173], v[46:47] op_sel_hi:[1,0]
    v_pk_add_f32 v[174:175], v[174:175], v[46:47] op_sel_hi:[1,0]
    v_exp_f32 v168, v168
    v_exp_f32 v169, v169
    v_exp_f32 v170, v170
    v_exp_f32 v171, v171
    v_exp_f32 v172, v172
    v_exp_f32 v173, v173
    v_exp_f32 v174, v174
    v_exp_f32 v175, v175
    v_cvt_pk_bf16_f32 v12, v168, v169
    v_cvt_pk_bf16_f32 v13, v170, v171
    v_cvt_pk_bf16_f32 v14, v172, v173
    v_cvt_pk_bf16_f32 v15, v174, v175
    s_nop 1
    v_mfma_f32_32x32x16_bf16 v[208:223], v[28:31], v[12:15], v[208:223]
    ds_read_b64_tr_b16 v[24:25], v42 offset:4096
    ds_read_b64_tr_b16 v[26:27], v42 offset:4224
    ds_read_b64_tr_b16 v[28:29], v42 offset:4352
    ds_read_b64_tr_b16 v[30:31], v42 offset:4480
    v_pk_add_f32 v[176:177], v[176:177], v[46:47] op_sel_hi:[1,0]
    v_pk_add_f32 v[178:179], v[178:179], v[46:47] op_sel_hi:[1,0]
    v_pk_add_f32 v[180:181], v[180:181], v[46:47] op_sel_hi:[1,0]
    v_pk_add_f32 v[182:183], v[182:183], v[46:47] op_sel_hi:[1,0]
    v_exp_f32 v176, v176
    v_exp_f32 v177, v177
    v_exp_f32 v178, v178
    v_exp_f32 v179, v179
    v_exp_f32 v180, v180
    v_exp_f32 v181, v181
    v_exp_f32 v182, v182
    v_exp_f32 v183, v183
    v_cvt_pk_bf16_f32 v16, v176, v177
    v_cvt_pk_bf16_f32 v17, v178, v179
    v_cvt_pk_bf16_f32 v18, v180, v181
    v_cvt_pk_bf16_f32 v19, v182, v183
    s_waitcnt lgkmcnt(4)
    s_nop 0
    v_mfma_f32_32x32x16_bf16 v[208:223], v[32:35], v[16:19], v[208:223]
    v_pk_add_f32 v[184:185], v[184:185], v[46:47] op_sel_hi:[1,0]
    v_pk_add_f32 v[186:187], v[186:187], v[46:47] op_sel_hi:[1,0]
    v_pk_add_f32 v[188:189], v[188:189], v[46:47] op_sel_hi:[1,0]
    v_pk_add_f32 v[190:191], v[190:191], v[46:47] op_sel_hi:[1,0]
    v_exp_f32 v184, v184
    v_exp_f32 v185, v185
    v_exp_f32 v186, v186
    v_exp_f32 v187, v187
    v_exp_f32 v188, v188
    v_exp_f32 v189, v189
    v_exp_f32 v190, v190
    v_exp_f32 v191, v191
    v_cvt_pk_bf16_f32 v20, v184, v185
    v_cvt_pk_bf16_f32 v21, v186, v187
    v_cvt_pk_bf16_f32 v22, v188, v189
    v_cvt_pk_bf16_f32 v23, v190, v191
    s_nop 1
    v_mfma_f32_32x32x16_bf16 v[208:223], v[36:39], v[20:23], v[208:223]
    v_pk_add_f32 v[192:193], v[192:193], v[46:47] op_sel_hi:[1,0]
    v_pk_add_f32 v[194:195], v[194:195], v[46:47] op_sel_hi:[1,0]
    v_pk_add_f32 v[196:197], v[196:197], v[46:47] op_sel_hi:[1,0]
    v_pk_add_f32 v[198:199], v[198:199], v[46:47] op_sel_hi:[1,0]
    v_exp_f32 v192, v192
    v_exp_f32 v193, v193
    v_exp_f32 v194, v194
    v_exp_f32 v195, v195
    v_exp_f32 v196, v196
    v_exp_f32 v197, v197
    v_exp_f32 v198, v198
    v_exp_f32 v199, v199
    v_cvt_pk_bf16_f32 v8, v192, v193
    v_cvt_pk_bf16_f32 v9, v194, v195
    v_cvt_pk_bf16_f32 v10, v196, v197
    v_cvt_pk_bf16_f32 v11, v198, v199
    s_waitcnt lgkmcnt(0)
    s_nop 0
    v_mfma_f32_32x32x16_bf16 v[208:223], v[24:27], v[8:11], v[208:223]
    v_pk_add_f32 v[200:201], v[200:201], v[46:47] op_sel_hi:[1,0]
    v_pk_add_f32 v[202:203], v[202:203], v[46:47] op_sel_hi:[1,0]
    v_pk_add_f32 v[204:205], v[204:205], v[46:47] op_sel_hi:[1,0]
    v_pk_add_f32 v[206:207], v[206:207], v[46:47] op_sel_hi:[1,0]
    v_exp_f32 v200, v200
    v_exp_f32 v201, v201
    v_exp_f32 v202, v202
    v_exp_f32 v203, v203
    v_exp_f32 v204, v204
    v_exp_f32 v205, v205
    v_exp_f32 v206, v206
    v_exp_f32 v207, v207
    v_cvt_pk_bf16_f32 v12, v200, v201
    v_cvt_pk_bf16_f32 v13, v202, v203
    v_cvt_pk_bf16_f32 v14, v204, v205
    v_cvt_pk_bf16_f32 v15, v206, v207
    s_nop 1
    v_mfma_f32_32x32x16_bf16 v[208:223], v[28:31], v[12:15], v[208:223]
    s_branch Lnorm_40
Laxp_75:
    v_mov_b32 v2, 16384
    v_mov_b32 v3, 16
    s_mov_b32 s52, 40000
Lpoll_77:
    buffer_load_dword v1, v2, s[16:19], 0 offen sc1
    s_waitcnt vmcnt(0)
    v_cmp_le_u32 vcc, v3, v1
    s_cmp_eq_u64 vcc, -1
    s_cbranch_scc1 Lpolld_78
    s_sleep 1
    s_sub_u32 s52, s52, 1
    s_cmp_lg_u32 s52, 0
    s_cbranch_scc1 Lpoll_77
Lpolld_78:
    s_branch Laxb_76
Lw4_123:
    s_cmp_lg_u32 s52, 1
    s_cbranch_scc1 Lw20_124
    s_waitcnt vmcnt(4)
    s_branch Lwd_118
Lw20_124:
    s_cmp_lg_u32 s52, 2
    s_cbranch_scc1 Lw28_125
    s_waitcnt vmcnt(20)
    s_branch Lwd_118
Lw28_125:
    s_cmp_lg_u32 s52, 3
    s_cbranch_scc1 Lw13_126
    s_waitcnt vmcnt(28)
    s_branch Lwd_118
Lw13_126:
    s_cmp_lg_u32 s52, 4
    s_cbranch_scc1 Lw2_127
    s_waitcnt vmcnt(13)
    s_branch Lwd_118
Lw2_127:
    s_cmp_lg_u32 s52, 5
    s_cbranch_scc1 Lw0_128
    s_waitcnt vmcnt(2)
    s_branch Lwd_118
Lw0_128:
    s_waitcnt vmcnt(0)
    s_branch Lwd_118
Lact_120:
    s_cmp_eq_u32 s62, 6
    s_cbranch_scc1 La6_129
    s_cmp_eq_u32 s62, 8
    s_cbranch_scc1 La8_130
    v_add_f32 v24, v24, v26
    v_add_f32 v25, v25, v27
    v_add_f32 v24, v24, v28
    v_add_f32 v25, v25, v29
    v_add_f32 v24, v24, v30
    v_add_f32 v25, v25, v31
    v_add_f32 v24, v24, v32
    v_add_f32 v25, v25, v33
    v_add_f32 v24, v24, v34
    v_add_f32 v25, v25, v35
    v_add_f32 v24, v24, v36
    v_add_f32 v25, v25, v37
    v_add_f32 v24, v24, v38
    v_add_f32 v25, v25, v39
    v_add_f32 v24, v24, v40
    v_add_f32 v25, v25, v41
    v_add_f32 v24, v24, v42
    v_add_f32 v25, v25, v43
    v_add_f32 v24, v24, v44
    v_add_f32 v25, v25, v45
    v_add_f32 v24, v24, v46
    v_add_f32 v25, v25, v47
    v_add_f32 v24, v24, v48
    v_add_f32 v25, v25, v49
    v_add_f32 v24, v24, v50
    v_add_f32 v25, v25, v51
    v_add_f32 v24, v24, v52
    v_add_f32 v25, v25, v53
    v_add_f32 v24, v24, v54
    v_add_f32 v25, v25, v55
    s_mov_b32 s52, 0x3acccccd
    s_mov_b32 s53, 0x3727c5ac
    v_mul_f32 v24, s52, v24
    v_mul_f32 v25, s52, v25
    v_fma_f32 v25, -v24, v24, v25
    v_max_f32 v25, 0, v25
    v_add_f32 v25, s53, v25
    v_rcp_f32 v25, v25
    v_sub_f32 v24, 0, v24
    s_lshl_b32 s52, s31, 9
    s_add_u32 s52, s52, 147456
    v_add_u32 v2, s52, v2
    ds_write_b64 v2, v[24:25]
    s_waitcnt lgkmcnt(0)
    s_branch Lret_121
La6_129:
    buffer_load_dword v4, v3, s[16:19], 0 offen sc1
    s_mov_b32 s62, 8
    s_branch Lret_121
La8_130:
    v_readfirstlane_b32 s52, v4
    s_nop 3
    s_cmp_ge_u32 s52, 32
    s_cbranch_scc0 La8f_131
    buffer_load_dwordx2 v[24:25], v2, s[16:19], s63 offen sc1
    s_add_u32 s53, s63, 0x4000
    buffer_load_dwordx2 v[26:27], v2, s[16:19], s53 offen sc1
    s_add_u32 s53, s63, 0x8000
    buffer_load_dwordx2 v[28:29], v2, s[16:19], s53 offen sc1
    s_add_u32 s53, s63, 0xc000
    buffer_load_dwordx2 v[30:31], v2, s[16:19], s53 offen sc1
    s_mov_b32 s64, 1
    s_branch Lret_121
La8f_131:
    buffer_load_dword v4, v3, s[16:19], 0 offen sc1
    buffer_load_dword v4, v3, s[16:19], 0 offen sc1
    buffer_load_dword v4, v3, s[16:19], 0 offen sc1
    buffer_load_dword v4, v3, s[16:19], 0 offen sc1
    s_branch Lret_121
Lcodeend:
.section .rodata,"a"
.p2align 6
.amdhsa_kernel sequential_preLN__sliding_block__glu_gated_bilinear__prompt_kernel
  .amdhsa_next_free_vgpr 256
  .amdhsa_next_free_sgpr 102
  .amdhsa_accum_offset 256
  .amdhsa_group_segment_fixed_size 0
  .amdhsa_kernarg_size 80
  .amdhsa_user_sgpr_count 2
  .amdhsa_user_sgpr_kernarg_segment_ptr 1
  .amdhsa_system_sgpr_workgroup_id_x 1
  .amdhsa_float_denorm_mode_32 3
  .amdhsa_float_denorm_mode_16_64 3
.end_amdhsa_kernel
```
